```python
import torch

def _softmax(x, axis=-1):
    return torch.softmax(x, dim=axis)
def _gelu(x):
    return torch.nn.functional.gelu(x, approximate="tanh")
def _silu(x):
    return torch.nn.functional.silu(x)
def _sigmoid(x):
    return torch.sigmoid(x)
def _layernorm(x, axis=-1, eps=1e-5):
    m = x.mean(dim=axis, keepdim=True)
    v = x.var(dim=axis, keepdim=True, unbiased=False)
    return (x - m) / torch.sqrt(v + eps)
def _scatter_add(tgt, idx, src, axis=0):
    return tgt.clone().index_add_(axis, idx, src)
def _segment_sum(src, seg, n):
    out = torch.zeros((n,) + src.shape[1:], dtype=src.dtype)
    return out.index_add_(0, seg, src)
def _pad(x, pw):
    flat = tuple(v for pair in reversed(pw) for v in pair)
    return torch.nn.functional.pad(x, flat)

kernel_name = 'gated_mix__mha_block__mha_block__prompt'

def setup_inputs():

    _w = (lambda a: (lambda t: t.to(torch.bfloat16) if t.is_floating_point() else t)(torch.as_tensor(a)))
    def _A_setup():
        B, S, D, H = 1, 2048, 448, 16
        return {
            "x": _w((lambda *s: torch.randn(*s, dtype=torch.bfloat16) * 0.05)(B, S, D)),
            "wqkv": _w((lambda *s: torch.randn(*s, dtype=torch.bfloat16) * 0.8)(D, 3 * D)),
            "wo": _w((lambda *s: torch.randn(*s, dtype=torch.bfloat16) * 0.05)(D, D)),
        }
    _A_in = _A_setup()

    def _B_setup():
        B, S, D, H = 1, 2048, 448, 16
        return {
            "x": _w((lambda *s: torch.randn(*s, dtype=torch.bfloat16) * 0.05)(B, S, D)),
            "wqkv": _w((lambda *s: torch.randn(*s, dtype=torch.bfloat16) * 0.8)(D, 3 * D)),
            "wo": _w((lambda *s: torch.randn(*s, dtype=torch.bfloat16) * 0.05)(D, D)),
        }
    _B_in = _B_setup()

    return {
        "A_x": _A_in["x"],
        "A_wqkv": _A_in["wqkv"],
        "A_wo": _A_in["wo"],
        "B_x": _B_in["x"],
        "B_wqkv": _B_in["wqkv"],
        "B_wo": _B_in["wo"],
        "gate_w": _w((lambda *s: torch.randn(*s, dtype=torch.bfloat16) * 0.05)(448) * 16.0),
    }

def reference(A_x, A_wqkv, A_wo, B_x, B_wqkv, B_wo, gate_w):
    def _A_ref(x, wqkv, wo):
        B, S, D = x.shape
        H = 16
        Dh = D // H
        qkv = (lambda x, *d: x.permute(*d))((x @ wqkv).reshape(B, S, 3, H, Dh), 2, 0, 3, 1, 4)
        q, k, v = qkv[0], qkv[1], qkv[2]
        scores = torch.einsum("bhqd,bhkd->bhqk", q, k) * (Dh ** -0.5)
        p = _softmax(scores, axis=-1)
        o = torch.einsum("bhqk,bhkd->bhqd", p, v)
        return (lambda x, *d: x.permute(*d))(o, 0, 2, 1, 3).reshape(B, S, D) @ wo

    def _B_ref(x, wqkv, wo):
        B, S, D = x.shape
        H = 16
        Dh = D // H
        qkv = (lambda x, *d: x.permute(*d))((x @ wqkv).reshape(B, S, 3, H, Dh), 2, 0, 3, 1, 4)
        q, k, v = qkv[0], qkv[1], qkv[2]
        scores = torch.einsum("bhqd,bhkd->bhqk", q, k) * (Dh ** -0.5)
        p = _softmax(scores, axis=-1)
        o = torch.einsum("bhqk,bhkd->bhqd", p, v)
        return (lambda x, *d: x.permute(*d))(o, 0, 2, 1, 3).reshape(B, S, D) @ wo

    x = A_x
    g = _sigmoid((x * gate_w).sum(-1, keepdims=True))
    a = _A_ref(x, A_wqkv, A_wo)
    b = _B_ref(x, B_wqkv, B_wo)
    return g * a + (1 - g) * b
```

```asm
; @launch grid=(256,1,1) block=(512,1,1) lds=163840
.amdgcn_target "amdgcn-amd-amdhsa--gfx950"
.text
.globl gated_mix__mha_block__mha_block__prompt_kernel
.p2align 8
.type gated_mix__mha_block__mha_block__prompt_kernel,@function
gated_mix__mha_block__mha_block__prompt_kernel:
    s_cmp_ge_u32 s2, 256
    s_cbranch_scc1 K_END
    s_load_dwordx4 s[4:7], s[0:1], 0
    s_load_dwordx2 s[76:77], s[0:1], 32
    s_load_dwordx2 s[78:79], s[0:1], 16
    s_load_dwordx4 s[80:83], s[0:1], 40
    s_load_dwordx2 s[84:85], s[0:1], 56
    s_load_dwordx4 s[88:91], s[0:1], 64
    s_mov_b32 s72, 542246176
    s_mov_b32 s73, 20997
    v_lshrrev_b32 v1, 6, v0
    v_and_b32 v0, 63, v0
    v_readfirstlane_b32 s48, v1
    s_lshr_b32 s54, s2, 3
    s_mul_i32 s55, s54, 37
    s_lshr_b32 s55, s55, 8
    s_mul_i32 s56, s55, 7
    s_sub_u32 s52, s54, s56
    s_and_b32 s53, s2, 6
    s_lshl_b32 s53, s53, 1
    s_add_u32 s53, s53, s55
    v_lshlrev_b32 v1, 4, v0
    v_lshrrev_b32 v80, 3, v0
    v_mul_u32_u24 v83, 896, v80
    v_lshrrev_b32 v81, 4, v0
    v_and_b32 v82, 7, v0
    v_xor_b32 v84, v81, v82
    v_lshl_add_u32 v2, v84, 4, v83
    v_xor_b32 v84, 4, v84
    v_lshl_add_u32 v3, v84, 4, v83
    v_add_u32 v3, 6144, v3
    v_mul_u32_u24 v83, 2688, v80
    v_and_b32 v81, 1, v81
    v_lshlrev_b32 v81, 2, v81
    v_xor_b32 v81, v81, v82
    v_lshl_add_u32 v4, v81, 4, v83
    s_lshl_b32 s56, s53, 3
    s_add_u32 s56, s56, s48
    s_mul_i32 s58, s56, 14336
    s_mul_i32 s59, s48, 21504
    s_lshl_b32 s56, s52, 7
    s_add_u32 s59, s59, s56
    s_lshl_b32 s60, s48, 11
    s_lshl_b32 s61, s48, 10
    s_add_u32 s56, s52, s55
    s_lshl_b32 s56, s56, 2
    s_lshr_b64 s[56:57], s[72:73], s56
    s_and_b32 s56, s56, 7
    s_add_u32 s64, s58, 896
    s_lshl_b32 s62, s56, 7
    s_add_u32 s62, s62, s58
    s_mul_i32 s63, s56, 172032
    s_add_u32 s63, s63, s59
    s_bitcmp1_b32 s2, 0
    s_waitcnt lgkmcnt(0)
    s_cselect_b32 s12, s76, s6
    s_cselect_b32 s13, s77, s7
    s_mov_b32 s14, 1204224
    s_mov_b32 s15, 0x00020000
    s_mov_b32 s8, s4
    s_mov_b32 s9, s5
    s_mov_b32 s10, 1835008
    s_mov_b32 s11, 0x00020000
    s_cmp_ge_u32 s2, 224
    s_cbranch_scc1 K_IDLE
    s_add_u32 m0, s60, 0
    s_nop 0
    buffer_load_dwordx4 v2, s[8:11], s62 offen offset:0 lds
    buffer_load_dwordx4 v3, s[8:11], s62 offen offset:1024 lds
    s_add_u32 m0, s61, 15488
    s_nop 0
    buffer_load_dwordx4 v4, s[12:15], s63 offen offset:896 lds
    s_add_u32 m0, s61, 22784
    s_nop 0
    buffer_load_dwordx4 v4, s[12:15], s63 offen offset:1792 lds
    s_add_u32 s62, s62, 128
    s_add_u32 s63, s63, 172032
    s_cmp_eq_u32 s62, s64
    s_cselect_b32 s62, s58, s62
    s_cselect_b32 s63, s59, s63
    s_and_b32 s54, s2, 7
    s_bfe_u32 s69, s2, 0x20003
    s_lshr_b32 s50, s2, 5
    s_lshl_b32 s49, s54, 2
    s_add_u32 s49, s49, s69
    s_lshl_b32 s68, s50, 3
    s_add_u32 s68, s68, s54
    s_and_b32 s51, s49, 15
    s_mov_b32 s28, s78
    s_mov_b32 s29, s79
    s_mov_b32 s30, 401408
    s_mov_b32 s31, 0x00020000
    s_mov_b32 s32, s80
    s_mov_b32 s33, s81
    s_mov_b32 s34, 401408
    s_mov_b32 s35, 0x00020000
    s_mov_b32 s36, s82
    s_mov_b32 s37, s83
    s_mov_b32 s38, 896
    s_mov_b32 s39, 0x00020000
    s_mov_b32 s40, s84
    s_mov_b32 s41, s85
    s_mov_b32 s42, 1835008
    s_mov_b32 s43, 0x00020000
    s_mov_b32 s16, s90
    s_mov_b32 s17, s91
    s_mov_b32 s18, 11010048
    s_mov_b32 s19, 0x00020000
    s_add_u32 s24, s90, 11534336
    s_addc_u32 s25, s91, 0
    s_mov_b32 s26, 65792
    s_mov_b32 s27, 0x00020000
    s_load_dwordx2 s[74:75], s[24:25], 65536
    s_add_u32 s20, s90, 12582912
    s_addc_u32 s21, s91, 0
    s_mov_b32 s22, 4194304
    s_mov_b32 s23, 0x00020000
    s_and_b32 s54, s48, 1
    s_lshl_b32 s54, s54, 2
    v_lshrrev_b32 v80, 4, v0
    v_mul_u32_u24 v81, 896, v80
    v_or_b32 v80, s54, v80
    v_bfe_u32 v82, v0, 1, 3
    v_xor_b32 v80, v80, v82
    v_lshl_add_u32 v81, v80, 5, v81
    v_and_b32 v80, 1, v0
    v_lshl_add_u32 v12, v80, 4, v81
    s_mul_i32 s4, s48, 3584
    s_lshl_b32 s54, s69, 8
    s_add_u32 s4, s4, s54
    s_lshl_b32 s5, s48, 10
    v_lshrrev_b32 v80, 4, v0
    v_mul_u32_u24 v81, 896, v80
    v_bfe_u32 v82, v0, 1, 3
    v_xor_b32 v80, v80, v82
    v_and_b32 v82, 1, v0
    v_lshl_add_u32 v81, v82, 4, v81
    v_lshl_add_u32 v116, v80, 5, v81
    v_xor_b32 v80, 4, v80
    v_lshl_add_u32 v80, v80, 5, v81
    v_add_u32 v117, 2560, v80
    v_add_u32 v118, 5120, v116
    v_add_u32 v119, 7680, v80
    s_mul_i32 s6, s48, 10752
    s_add_u32 s6, s6, s4
    s_lshl_b32 s0, s48, 12
    s_barrier
    s_add_u32 m0, s60, 32768
    s_nop 0
    buffer_load_dwordx4 v2, s[8:11], s62 offen offset:0 lds
    buffer_load_dwordx4 v3, s[8:11], s62 offen offset:1024 lds
    s_add_u32 m0, s61, 48256
    s_nop 0
    buffer_load_dwordx4 v4, s[12:15], s63 offen offset:896 lds
    s_add_u32 m0, s61, 55552
    s_nop 0
    buffer_load_dwordx4 v4, s[12:15], s63 offen offset:1792 lds
    s_add_u32 s62, s62, 128
    s_add_u32 s63, s63, 172032
    s_cmp_eq_u32 s62, s64
    s_cselect_b32 s62, s58, s62
    s_cselect_b32 s63, s59, s63
    v_lshrrev_b32 v80, 5, v0
    v_lshlrev_b32 v80, 10, v80
    v_bfe_u32 v81, v0, 2, 2
    v_lshl_add_u32 v80, v81, 7, v80
    s_lshr_b32 s54, s48, 2
    v_bfe_u32 v81, v0, 3, 1
    v_xor_b32 v81, s54, v81
    v_lshl_add_u32 v80, v81, 6, v80
    v_bfe_u32 v81, v0, 4, 1
    v_lshl_add_u32 v80, v81, 5, v80
    v_add_u32 v80, 16384, v80
    v_and_b32 v81, 3, v0
    v_lshl_add_u32 v6, v81, 3, v80
    v_and_b32 v81, 1, v0
    v_lshl_add_u32 v80, v81, 4, v80
    v_bfe_u32 v81, v0, 1, 1
    v_lshl_add_u32 v5, v81, 3, v80
    v_add_u32 v7, 49152, v5
    s_and_b32 s54, s48, 3
    s_lshl_b32 s54, s54, 12
    v_and_b32 v80, 31, v0
    v_lshrrev_b32 v81, 5, v0
    v_bfe_u32 v82, v0, 1, 3
    v_xor_b32 v81, v81, v82
    v_lshlrev_b32 v80, 7, v80
    v_add_u32 v80, s54, v80
    v_xor_b32 v82, 0, v81
    v_lshl_add_u32 v8, v82, 4, v80
    v_xor_b32 v82, 2, v81
    v_lshl_add_u32 v9, v82, 4, v80
    v_xor_b32 v82, 4, v81
    v_lshl_add_u32 v10, v82, 4, v80
    v_xor_b32 v82, 6, v81
    v_lshl_add_u32 v11, v82, 4, v80
    s_waitcnt vmcnt(4)
    s_barrier
    ds_read_b128 v[128:131], v8
    ds_read_b64_tr_b16 v[96:97], v5 offset:0
    ds_read_b64_tr_b16 v[98:99], v5 offset:512
    ds_read_b64_tr_b16 v[100:101], v6 offset:8192
    ds_read_b64_tr_b16 v[102:103], v6 offset:8704
    ds_read_b128 v[132:135], v9
    ds_read_b64_tr_b16 v[104:105], v5 offset:2048
    ds_read_b64_tr_b16 v[106:107], v5 offset:2560
    ds_read_b64_tr_b16 v[108:109], v6 offset:10240
    ds_read_b64_tr_b16 v[110:111], v6 offset:10752
    s_waitcnt lgkmcnt(5)
    v_mfma_f32_32x32x16_bf16 v[32:47], v[96:99], v[128:131], 0
    ds_read_b128 v[136:139], v10
    ds_read_b64_tr_b16 v[240:241], v5 offset:4096
    ds_read_b64_tr_b16 v[242:243], v5 offset:4608
    ds_read_b64_tr_b16 v[244:245], v6 offset:12288
    ds_read_b64_tr_b16 v[246:247], v6 offset:12800
    v_mfma_f32_32x32x16_bf16 v[48:63], v[128:131], v[100:103], 0
    s_add_u32 m0, s60, 65536
    s_nop 0
    buffer_load_dwordx4 v2, s[8:11], s62 offen offset:0 lds
    buffer_load_dwordx4 v3, s[8:11], s62 offen offset:1024 lds
    s_waitcnt lgkmcnt(5)
    v_mfma_f32_32x32x16_bf16 v[32:47], v[104:107], v[132:135], v[32:47]
    ds_read_b128 v[140:143], v11
    ds_read_b64_tr_b16 v[96:97], v5 offset:6144
    ds_read_b64_tr_b16 v[98:99], v5 offset:6656
    ds_read_b64_tr_b16 v[100:101], v6 offset:14336
    ds_read_b64_tr_b16 v[102:103], v6 offset:14848
    v_mfma_f32_32x32x16_bf16 v[48:63], v[132:135], v[108:111], v[48:63]
    s_add_u32 m0, s61, 81024
    s_nop 0
    buffer_load_dwordx4 v4, s[12:15], s63 offen offset:896 lds
    s_add_u32 m0, s61, 88320
    s_nop 0
    buffer_load_dwordx4 v4, s[12:15], s63 offen offset:1792 lds
    s_add_u32 s62, s62, 128
    s_add_u32 s63, s63, 172032
    s_cmp_eq_u32 s62, s64
    s_cselect_b32 s62, s58, s62
    s_cselect_b32 s63, s59, s63
    s_waitcnt lgkmcnt(5)
    v_mfma_f32_32x32x16_bf16 v[32:47], v[240:243], v[136:139], v[32:47]
    v_add_u32 v5, 32768, v5
    v_add_u32 v8, 32768, v8
    v_add_u32 v9, 32768, v9
    v_add_u32 v10, 32768, v10
    v_add_u32 v11, 32768, v11
    v_add_u32 v6, 32768, v6
    s_waitcnt vmcnt(4)
    s_barrier
    ds_read_b128 v[144:147], v8
    ds_read_b64_tr_b16 v[104:105], v5 offset:0
    ds_read_b64_tr_b16 v[106:107], v5 offset:512
    ds_read_b64_tr_b16 v[108:109], v6 offset:8192
    ds_read_b64_tr_b16 v[110:111], v6 offset:8704
    v_mfma_f32_32x32x16_bf16 v[48:63], v[136:139], v[244:247], v[48:63]
    s_add_u32 m0, s60, 98304
    s_nop 0
    buffer_load_dwordx4 v2, s[8:11], s62 offen offset:0 lds
    buffer_load_dwordx4 v3, s[8:11], s62 offen offset:1024 lds
    s_waitcnt lgkmcnt(5)
    v_mfma_f32_32x32x16_bf16 v[32:47], v[96:99], v[140:143], v[32:47]
    ds_read_b128 v[148:151], v9
    ds_read_b64_tr_b16 v[240:241], v5 offset:2048
    ds_read_b64_tr_b16 v[242:243], v5 offset:2560
    ds_read_b64_tr_b16 v[244:245], v6 offset:10240
    ds_read_b64_tr_b16 v[246:247], v6 offset:10752
    v_mfma_f32_32x32x16_bf16 v[48:63], v[140:143], v[100:103], v[48:63]
    s_add_u32 m0, s61, 113792
    s_nop 0
    buffer_load_dwordx4 v4, s[12:15], s63 offen offset:896 lds
    s_add_u32 m0, s61, 121088
    s_nop 0
    buffer_load_dwordx4 v4, s[12:15], s63 offen offset:1792 lds
    s_add_u32 s62, s62, 128
    s_add_u32 s63, s63, 172032
    s_cmp_eq_u32 s62, s64
    s_cselect_b32 s62, s58, s62
    s_cselect_b32 s63, s59, s63
    s_waitcnt lgkmcnt(5)
    v_mfma_f32_32x32x16_bf16 v[32:47], v[104:107], v[144:147], v[32:47]
    ds_read_b128 v[152:155], v10
    ds_read_b64_tr_b16 v[96:97], v5 offset:4096
    ds_read_b64_tr_b16 v[98:99], v5 offset:4608
    ds_read_b64_tr_b16 v[100:101], v6 offset:12288
    ds_read_b64_tr_b16 v[102:103], v6 offset:12800
    v_mfma_f32_32x32x16_bf16 v[48:63], v[144:147], v[108:111], v[48:63]
    s_add_u32 m0, s60, 131072
    s_nop 0
    buffer_load_dwordx4 v2, s[8:11], s62 offen offset:0 lds
    s_waitcnt lgkmcnt(5)
    v_mfma_f32_32x32x16_bf16 v[32:47], v[240:243], v[148:151], v[32:47]
    ds_read_b128 v[156:159], v11
    ds_read_b64_tr_b16 v[104:105], v5 offset:6144
    ds_read_b64_tr_b16 v[106:107], v5 offset:6656
    ds_read_b64_tr_b16 v[108:109], v6 offset:14336
    ds_read_b64_tr_b16 v[110:111], v6 offset:14848
    v_mfma_f32_32x32x16_bf16 v[48:63], v[148:151], v[244:247], v[48:63]
    buffer_load_dwordx4 v3, s[8:11], s62 offen offset:1024 lds
    s_waitcnt lgkmcnt(5)
    v_mfma_f32_32x32x16_bf16 v[32:47], v[96:99], v[152:155], v[32:47]
    v_add_u32 v5, 32768, v5
    v_add_u32 v8, 32768, v8
    v_add_u32 v9, 32768, v9
    v_add_u32 v10, 32768, v10
    v_add_u32 v11, 32768, v11
    v_add_u32 v6, 32768, v6
    s_waitcnt vmcnt(6)
    s_barrier
    ds_read_b128 v[160:163], v8
    ds_read_b64_tr_b16 v[240:241], v5 offset:0
    ds_read_b64_tr_b16 v[242:243], v5 offset:512
    ds_read_b64_tr_b16 v[244:245], v6 offset:8192
    ds_read_b64_tr_b16 v[246:247], v6 offset:8704
    v_mfma_f32_32x32x16_bf16 v[48:63], v[152:155], v[100:103], v[48:63]
    s_add_u32 m0, s61, 146560
    s_nop 0
    buffer_load_dwordx4 v4, s[12:15], s63 offen offset:896 lds
    s_waitcnt lgkmcnt(5)
    v_mfma_f32_32x32x16_bf16 v[32:47], v[104:107], v[156:159], v[32:47]
    ds_read_b128 v[164:167], v9
    ds_read_b64_tr_b16 v[96:97], v5 offset:2048
    ds_read_b64_tr_b16 v[98:99], v5 offset:2560
    ds_read_b64_tr_b16 v[100:101], v6 offset:10240
    ds_read_b64_tr_b16 v[102:103], v6 offset:10752
    v_mfma_f32_32x32x16_bf16 v[48:63], v[156:159], v[108:111], v[48:63]
    s_add_u32 m0, s61, 153856
    s_nop 0
    buffer_load_dwordx4 v4, s[12:15], s63 offen offset:1792 lds
    s_add_u32 s62, s62, 128
    s_add_u32 s63, s63, 172032
    s_cmp_eq_u32 s62, s64
    s_cselect_b32 s62, s58, s62
    s_cselect_b32 s63, s59, s63
    s_waitcnt lgkmcnt(5)
    v_mfma_f32_32x32x16_bf16 v[32:47], v[240:243], v[160:163], v[32:47]
    ds_read_b128 v[168:171], v10
    ds_read_b64_tr_b16 v[104:105], v5 offset:4096
    ds_read_b64_tr_b16 v[106:107], v5 offset:4608
    ds_read_b64_tr_b16 v[108:109], v6 offset:12288
    ds_read_b64_tr_b16 v[110:111], v6 offset:12800
    v_mfma_f32_32x32x16_bf16 v[48:63], v[160:163], v[244:247], v[48:63]
    s_add_u32 m0, s60, 0
    s_nop 0
    buffer_load_dwordx4 v2, s[8:11], s62 offen offset:0 lds
    s_waitcnt lgkmcnt(5)
    v_mfma_f32_32x32x16_bf16 v[32:47], v[96:99], v[164:167], v[32:47]
    ds_read_b128 v[172:175], v11
    ds_read_b64_tr_b16 v[240:241], v5 offset:6144
    ds_read_b64_tr_b16 v[242:243], v5 offset:6656
    ds_read_b64_tr_b16 v[244:245], v6 offset:14336
    ds_read_b64_tr_b16 v[246:247], v6 offset:14848
    v_mfma_f32_32x32x16_bf16 v[48:63], v[164:167], v[100:103], v[48:63]
    buffer_load_dwordx4 v3, s[8:11], s62 offen offset:1024 lds
    s_waitcnt lgkmcnt(5)
    v_mfma_f32_32x32x16_bf16 v[32:47], v[104:107], v[168:171], v[32:47]
    v_add_u32 v5, 32768, v5
    v_add_u32 v8, 32768, v8
    v_add_u32 v9, 32768, v9
    v_add_u32 v10, 32768, v10
    v_add_u32 v11, 32768, v11
    v_add_u32 v6, 32768, v6
    s_waitcnt vmcnt(6)
    s_barrier
    ds_read_b128 v[176:179], v8
    ds_read_b64_tr_b16 v[96:97], v5 offset:0
    ds_read_b64_tr_b16 v[98:99], v5 offset:512
    ds_read_b64_tr_b16 v[100:101], v6 offset:8192
    ds_read_b64_tr_b16 v[102:103], v6 offset:8704
    v_mfma_f32_32x32x16_bf16 v[48:63], v[168:171], v[108:111], v[48:63]
    s_add_u32 m0, s61, 15488
    s_nop 0
    buffer_load_dwordx4 v4, s[12:15], s63 offen offset:896 lds
    s_waitcnt lgkmcnt(5)
    v_mfma_f32_32x32x16_bf16 v[32:47], v[240:243], v[172:175], v[32:47]
    ds_read_b128 v[180:183], v9
    ds_read_b64_tr_b16 v[104:105], v5 offset:2048
    ds_read_b64_tr_b16 v[106:107], v5 offset:2560
    ds_read_b64_tr_b16 v[108:109], v6 offset:10240
    ds_read_b64_tr_b16 v[110:111], v6 offset:10752
    v_mfma_f32_32x32x16_bf16 v[48:63], v[172:175], v[244:247], v[48:63]
    s_add_u32 m0, s61, 22784
    s_nop 0
    buffer_load_dwordx4 v4, s[12:15], s63 offen offset:1792 lds
    s_add_u32 s62, s62, 128
    s_add_u32 s63, s63, 172032
    s_cmp_eq_u32 s62, s64
    s_cselect_b32 s62, s58, s62
    s_cselect_b32 s63, s59, s63
    s_waitcnt lgkmcnt(5)
    v_mfma_f32_32x32x16_bf16 v[32:47], v[96:99], v[176:179], v[32:47]
    ds_read_b128 v[184:187], v10
    ds_read_b64_tr_b16 v[240:241], v5 offset:4096
    ds_read_b64_tr_b16 v[242:243], v5 offset:4608
    ds_read_b64_tr_b16 v[244:245], v6 offset:12288
    ds_read_b64_tr_b16 v[246:247], v6 offset:12800
    v_mfma_f32_32x32x16_bf16 v[48:63], v[176:179], v[100:103], v[48:63]
    s_add_u32 m0, s60, 32768
    s_nop 0
    buffer_load_dwordx4 v2, s[8:11], s62 offen offset:0 lds
    s_waitcnt lgkmcnt(5)
    v_mfma_f32_32x32x16_bf16 v[32:47], v[104:107], v[180:183], v[32:47]
    ds_read_b128 v[188:191], v11
    ds_read_b64_tr_b16 v[96:97], v5 offset:6144
    ds_read_b64_tr_b16 v[98:99], v5 offset:6656
    ds_read_b64_tr_b16 v[100:101], v6 offset:14336
    ds_read_b64_tr_b16 v[102:103], v6 offset:14848
    v_mfma_f32_32x32x16_bf16 v[48:63], v[180:183], v[108:111], v[48:63]
    buffer_load_dwordx4 v3, s[8:11], s62 offen offset:1024 lds
    s_waitcnt lgkmcnt(5)
    v_mfma_f32_32x32x16_bf16 v[32:47], v[240:243], v[184:187], v[32:47]
    v_add_u32 v5, 32768, v5
    v_add_u32 v8, 32768, v8
    v_add_u32 v9, 32768, v9
    v_add_u32 v10, 32768, v10
    v_add_u32 v11, 32768, v11
    v_add_u32 v6, 32768, v6
    s_waitcnt vmcnt(6)
    s_barrier
    ds_read_b128 v[192:195], v8
    ds_read_b64_tr_b16 v[104:105], v5 offset:0
    ds_read_b64_tr_b16 v[106:107], v5 offset:512
    ds_read_b64_tr_b16 v[108:109], v6 offset:8192
    ds_read_b64_tr_b16 v[110:111], v6 offset:8704
    v_mfma_f32_32x32x16_bf16 v[48:63], v[184:187], v[244:247], v[48:63]
    s_add_u32 m0, s61, 48256
    s_nop 0
    buffer_load_dwordx4 v4, s[12:15], s63 offen offset:896 lds
    s_waitcnt lgkmcnt(5)
    v_mfma_f32_32x32x16_bf16 v[32:47], v[96:99], v[188:191], v[32:47]
    ds_read_b128 v[196:199], v9
    ds_read_b64_tr_b16 v[240:241], v5 offset:2048
    ds_read_b64_tr_b16 v[242:243], v5 offset:2560
    ds_read_b64_tr_b16 v[244:245], v6 offset:10240
    ds_read_b64_tr_b16 v[246:247], v6 offset:10752
    v_mfma_f32_32x32x16_bf16 v[48:63], v[188:191], v[100:103], v[48:63]
    s_add_u32 m0, s61, 55552
    s_nop 0
    buffer_load_dwordx4 v4, s[12:15], s63 offen offset:1792 lds
    s_add_u32 s62, s62, 128
    s_add_u32 s63, s63, 172032
    s_cmp_eq_u32 s62, s64
    s_cselect_b32 s62, s58, s62
    s_cselect_b32 s63, s59, s63
    s_waitcnt lgkmcnt(5)
    v_mfma_f32_32x32x16_bf16 v[32:47], v[104:107], v[192:195], v[32:47]
    ds_read_b128 v[200:203], v10
    ds_read_b64_tr_b16 v[96:97], v5 offset:4096
    ds_read_b64_tr_b16 v[98:99], v5 offset:4608
    ds_read_b64_tr_b16 v[100:101], v6 offset:12288
    ds_read_b64_tr_b16 v[102:103], v6 offset:12800
    v_mfma_f32_32x32x16_bf16 v[48:63], v[192:195], v[108:111], v[48:63]
    s_add_u32 m0, s61, 65536
    s_nop 0
    buffer_load_dwordx4 v4, s[12:15], s63 offen offset:0 lds
    s_add_u32 s62, s62, 128
    s_add_u32 s63, s63, 172032
    s_cmp_eq_u32 s62, s64
    s_cselect_b32 s62, s58, s62
    s_cselect_b32 s63, s59, s63
    s_waitcnt lgkmcnt(5)
    v_mfma_f32_32x32x16_bf16 v[32:47], v[240:243], v[196:199], v[32:47]
    ds_read_b128 v[204:207], v11
    ds_read_b64_tr_b16 v[104:105], v5 offset:6144
    ds_read_b64_tr_b16 v[106:107], v5 offset:6656
    ds_read_b64_tr_b16 v[108:109], v6 offset:14336
    ds_read_b64_tr_b16 v[110:111], v6 offset:14848
    v_mfma_f32_32x32x16_bf16 v[48:63], v[196:199], v[244:247], v[48:63]
    s_add_u32 m0, s61, 73728
    s_nop 0
    buffer_load_dwordx4 v4, s[12:15], s63 offen offset:0 lds
    s_add_u32 s62, s62, 128
    s_add_u32 s63, s63, 172032
    s_cmp_eq_u32 s62, s64
    s_cselect_b32 s62, s58, s62
    s_cselect_b32 s63, s59, s63
    s_waitcnt lgkmcnt(5)
    v_mfma_f32_32x32x16_bf16 v[32:47], v[96:99], v[200:203], v[32:47]
    v_add_u32 v5, -131072, v5
    v_add_u32 v8, -131072, v8
    v_add_u32 v9, -131072, v9
    v_add_u32 v10, -131072, v10
    v_add_u32 v11, -131072, v11
    v_add_u32 v6, -131072, v6
    s_waitcnt vmcnt(6)
    s_barrier
    ds_read_b128 v[208:211], v8
    ds_read_b64_tr_b16 v[240:241], v5 offset:0
    ds_read_b64_tr_b16 v[242:243], v5 offset:512
    ds_read_b64_tr_b16 v[244:245], v6 offset:8192
    ds_read_b64_tr_b16 v[246:247], v6 offset:8704
    v_mfma_f32_32x32x16_bf16 v[48:63], v[200:203], v[100:103], v[48:63]
    s_add_u32 m0, s61, 81920
    s_nop 0
    buffer_load_dwordx4 v4, s[12:15], s63 offen offset:0 lds
    s_add_u32 s62, s62, 128
    s_add_u32 s63, s63, 172032
    s_cmp_eq_u32 s62, s64
    s_cselect_b32 s62, s58, s62
    s_cselect_b32 s63, s59, s63
    s_waitcnt lgkmcnt(5)
    v_mfma_f32_32x32x16_bf16 v[32:47], v[104:107], v[204:207], v[32:47]
    ds_read_b128 v[212:215], v9
    ds_read_b64_tr_b16 v[96:97], v5 offset:2048
    ds_read_b64_tr_b16 v[98:99], v5 offset:2560
    ds_read_b64_tr_b16 v[100:101], v6 offset:10240
    ds_read_b64_tr_b16 v[102:103], v6 offset:10752
    v_mfma_f32_32x32x16_bf16 v[48:63], v[204:207], v[108:111], v[48:63]
    s_add_u32 m0, s61, 90112
    s_nop 0
    buffer_load_dwordx4 v4, s[12:15], s63 offen offset:0 lds
    s_add_u32 s62, s62, 128
    s_add_u32 s63, s63, 172032
    s_cmp_eq_u32 s62, s64
    s_cselect_b32 s62, s58, s62
    s_cselect_b32 s63, s59, s63
    s_waitcnt lgkmcnt(5)
    v_mfma_f32_32x32x16_bf16 v[32:47], v[240:243], v[208:211], v[32:47]
    ds_read_b128 v[216:219], v10
    ds_read_b64_tr_b16 v[104:105], v5 offset:4096
    ds_read_b64_tr_b16 v[106:107], v5 offset:4608
    ds_read_b64_tr_b16 v[108:109], v6 offset:12288
    ds_read_b64_tr_b16 v[110:111], v6 offset:12800
    v_mfma_f32_32x32x16_bf16 v[48:63], v[208:211], v[244:247], v[48:63]
    s_add_u32 m0, s61, 98304
    s_nop 0
    buffer_load_dwordx4 v4, s[12:15], s63 offen offset:0 lds
    s_add_u32 s62, s62, 128
    s_add_u32 s63, s63, 172032
    s_cmp_eq_u32 s62, s64
    s_cselect_b32 s62, s58, s62
    s_cselect_b32 s63, s59, s63
    s_waitcnt lgkmcnt(5)
    v_mfma_f32_32x32x16_bf16 v[32:47], v[96:99], v[212:215], v[32:47]
    ds_read_b128 v[220:223], v11
    ds_read_b64_tr_b16 v[240:241], v5 offset:6144
    ds_read_b64_tr_b16 v[242:243], v5 offset:6656
    ds_read_b64_tr_b16 v[244:245], v6 offset:14336
    ds_read_b64_tr_b16 v[246:247], v6 offset:14848
    v_mfma_f32_32x32x16_bf16 v[48:63], v[212:215], v[100:103], v[48:63]
    s_add_u32 m0, s61, 106496
    s_nop 0
    buffer_load_dwordx4 v4, s[12:15], s63 offen offset:0 lds
    s_add_u32 s62, s62, 128
    s_add_u32 s63, s63, 172032
    s_cmp_eq_u32 s62, s64
    s_cselect_b32 s62, s58, s62
    s_cselect_b32 s63, s59, s63
    s_waitcnt lgkmcnt(5)
    v_mfma_f32_32x32x16_bf16 v[32:47], v[104:107], v[216:219], v[32:47]
    v_add_u32 v5, 32768, v5
    v_add_u32 v8, 32768, v8
    v_add_u32 v9, 32768, v9
    v_add_u32 v10, 32768, v10
    v_add_u32 v11, 32768, v11
    v_add_u32 v6, 32768, v6
    s_waitcnt vmcnt(6)
    s_barrier
    ds_read_b128 v[224:227], v8
    ds_read_b64_tr_b16 v[96:97], v5 offset:0
    ds_read_b64_tr_b16 v[98:99], v5 offset:512
    ds_read_b64_tr_b16 v[100:101], v6 offset:8192
    ds_read_b64_tr_b16 v[102:103], v6 offset:8704
    v_mfma_f32_32x32x16_bf16 v[48:63], v[216:219], v[108:111], v[48:63]
    s_add_u32 m0, s61, 114688
    s_nop 0
    buffer_load_dwordx4 v4, s[12:15], s63 offen offset:0 lds
    s_waitcnt lgkmcnt(5)
    v_mfma_f32_32x32x16_bf16 v[32:47], v[240:243], v[220:223], v[32:47]
    ds_read_b128 v[228:231], v9
    ds_read_b64_tr_b16 v[104:105], v5 offset:2048
    ds_read_b64_tr_b16 v[106:107], v5 offset:2560
    ds_read_b64_tr_b16 v[108:109], v6 offset:10240
    ds_read_b64_tr_b16 v[110:111], v6 offset:10752
    v_mfma_f32_32x32x16_bf16 v[48:63], v[220:223], v[244:247], v[48:63]
    s_add_u32 m0, s0, 131072
    s_add_u32 s7, s6, 0
    buffer_load_dwordx4 v116, s[28:31], s7 offen offset:0 lds
    s_waitcnt lgkmcnt(5)
    v_mfma_f32_32x32x16_bf16 v[32:47], v[96:99], v[224:227], v[32:47]
    ds_read_b128 v[232:235], v10
    ds_read_b64_tr_b16 v[240:241], v5 offset:4096
    ds_read_b64_tr_b16 v[242:243], v5 offset:4608
    ds_read_b64_tr_b16 v[244:245], v6 offset:12288
    ds_read_b64_tr_b16 v[246:247], v6 offset:12800
    v_mfma_f32_32x32x16_bf16 v[48:63], v[224:227], v[100:103], v[48:63]
    buffer_load_dwordx4 v117, s[28:31], s7 offen offset:1024 lds
    s_waitcnt lgkmcnt(5)
    v_mfma_f32_32x32x16_bf16 v[32:47], v[104:107], v[228:231], v[32:47]
    ds_read_b128 v[236:239], v11
    ds_read_b64_tr_b16 v[96:97], v5 offset:6144
    ds_read_b64_tr_b16 v[98:99], v5 offset:6656
    ds_read_b64_tr_b16 v[100:101], v6 offset:14336
    ds_read_b64_tr_b16 v[102:103], v6 offset:14848
    v_mfma_f32_32x32x16_bf16 v[48:63], v[228:231], v[108:111], v[48:63]
    buffer_load_dwordx4 v118, s[28:31], s7 offen offset:2048 lds
    s_waitcnt lgkmcnt(5)
    v_mfma_f32_32x32x16_bf16 v[32:47], v[240:243], v[232:235], v[32:47]
    s_waitcnt vmcnt(7)
    s_barrier
    ds_read_b64_tr_b16 v[248:249], v7 offset:0
    ds_read_b64_tr_b16 v[250:251], v7 offset:512
    ds_read_b64_tr_b16 v[252:253], v7 offset:2048
    ds_read_b64_tr_b16 v[254:255], v7 offset:2560
    v_mfma_f32_32x32x16_bf16 v[48:63], v[232:235], v[244:247], v[48:63]
    buffer_load_dwordx4 v119, s[28:31], s7 offen offset:3072 lds
    v_bfe_u32 v85, v0, 2, 1
    v_bfe_u32 v86, v0, 3, 1
    v_and_b32 v87, 0x33, v0
    v_lshl_add_u32 v87, v85, 3, v87
    v_lshl_add_u32 v87, v86, 2, v87
    v_lshlrev_b32 v87, 4, v87
    v_lshrrev_b32 v85, 5, v0
    v_mul_u32_u24 v85, 6656, v85
    v_add_u32 v88, v85, v1
    s_and_b32 s54, s2, 1
    s_lshl_b32 s54, s54, 4
    s_add_u32 s54, s54, s53
    s_lshl_b32 s54, s54, 2
    s_and_b32 s55, s48, 3
    s_add_u32 s54, s54, s55
    s_mul_i32 s54, s54, 86016
    s_lshr_b32 s55, s48, 2
    s_lshl_b32 s56, s52, 1
    s_add_u32 s55, s55, s56
    s_lshl_b32 s56, s55, 9
    s_add_u32 s56, s56, s54
    s_add_u32 s56, s56, 57344
    s_add_u32 s57, s56, 14336
    s_lshl_b32 s55, s55, 11
    s_add_u32 s54, s54, s55
    s_add_u32 s55, s54, 28672
    s_waitcnt lgkmcnt(4)
    v_mfma_f32_32x32x16_bf16 v[32:47], v[96:99], v[236:239], v[32:47]
    ds_read_b64_tr_b16 v[104:105], v7 offset:4096
    ds_read_b64_tr_b16 v[106:107], v7 offset:4608
    v_mfma_f32_32x32x16_bf16 v[48:63], v[236:239], v[100:103], v[48:63]
    s_waitcnt lgkmcnt(4)
    v_mfma_f32_32x32x16_bf16 v[16:31], v[248:251], v[128:131], 0
    ds_read_b64_tr_b16 v[108:109], v7 offset:6144
    ds_read_b64_tr_b16 v[110:111], v7 offset:6656
    s_waitcnt lgkmcnt(4)
    v_mfma_f32_32x32x16_bf16 v[16:31], v[252:255], v[132:135], v[16:31]
    ds_read_b64_tr_b16 v[248:249], v7 offset:8192
    ds_read_b64_tr_b16 v[250:251], v7 offset:8704
    v_cvt_pk_bf16_f32 v64, v32, v33
    v_cvt_pk_bf16_f32 v65, v34, v35
    v_cvt_pk_bf16_f32 v66, v36, v37
    v_cvt_pk_bf16_f32 v67, v38, v39
    buffer_store_dwordx4 v[64:67], v87, s[16:19], s55 offen offset:0 sc1
    s_waitcnt lgkmcnt(4)
    v_mfma_f32_32x32x16_bf16 v[16:31], v[104:107], v[136:139], v[16:31]
    ds_read_b64_tr_b16 v[252:253], v7 offset:10240
    ds_read_b64_tr_b16 v[254:255], v7 offset:10752
    s_waitcnt lgkmcnt(4)
    v_mfma_f32_32x32x16_bf16 v[16:31], v[108:111], v[140:143], v[16:31]
    ds_read_b64_tr_b16 v[104:105], v7 offset:12288
    ds_read_b64_tr_b16 v[106:107], v7 offset:12800
    s_waitcnt lgkmcnt(4)
    v_mfma_f32_32x32x16_bf16 v[16:31], v[248:251], v[144:147], v[16:31]
    ds_read_b64_tr_b16 v[108:109], v7 offset:14336
    ds_read_b64_tr_b16 v[110:111], v7 offset:14848
    v_cvt_pk_bf16_f32 v68, v40, v41
    v_cvt_pk_bf16_f32 v69, v42, v43
    v_cvt_pk_bf16_f32 v70, v44, v45
    v_cvt_pk_bf16_f32 v71, v46, v47
    buffer_store_dwordx4 v[68:71], v87, s[16:19], s55 offen offset:1024 sc1
    s_waitcnt lgkmcnt(4)
    v_mfma_f32_32x32x16_bf16 v[16:31], v[252:255], v[148:151], v[16:31]
    ds_read_b64_tr_b16 v[248:249], v7 offset:16384
    ds_read_b64_tr_b16 v[250:251], v7 offset:16896
    s_waitcnt lgkmcnt(4)
    v_mfma_f32_32x32x16_bf16 v[16:31], v[104:107], v[152:155], v[16:31]
    ds_read_b64_tr_b16 v[252:253], v7 offset:18432
    ds_read_b64_tr_b16 v[254:255], v7 offset:18944
    s_waitcnt lgkmcnt(4)
    v_mfma_f32_32x32x16_bf16 v[16:31], v[108:111], v[156:159], v[16:31]
    ds_read_b64_tr_b16 v[104:105], v7 offset:20480
    ds_read_b64_tr_b16 v[106:107], v7 offset:20992
    v_cvt_pk_bf16_f32 v72, v48, v49
    v_cvt_pk_bf16_f32 v73, v50, v51
    v_cvt_pk_bf16_f32 v74, v52, v53
    v_cvt_pk_bf16_f32 v75, v54, v55
    buffer_store_dwordx4 v[72:75], v88, s[16:19], s56 offen sc1
    s_waitcnt lgkmcnt(4)
    v_mfma_f32_32x32x16_bf16 v[16:31], v[248:251], v[160:163], v[16:31]
    ds_read_b64_tr_b16 v[108:109], v7 offset:22528
    ds_read_b64_tr_b16 v[110:111], v7 offset:23040
    s_waitcnt lgkmcnt(4)
    v_mfma_f32_32x32x16_bf16 v[16:31], v[252:255], v[164:167], v[16:31]
    s_waitcnt vmcnt(7)
    s_barrier
    ds_read_b64_tr_b16 v[248:249], v7 offset:24576
    ds_read_b64_tr_b16 v[250:251], v7 offset:25088
    s_waitcnt lgkmcnt(4)
    v_mfma_f32_32x32x16_bf16 v[16:31], v[104:107], v[168:171], v[16:31]
    ds_read_b64_tr_b16 v[252:253], v7 offset:26624
    ds_read_b64_tr_b16 v[254:255], v7 offset:27136
    v_cvt_pk_bf16_f32 v76, v56, v57
    v_cvt_pk_bf16_f32 v77, v58, v59
    v_cvt_pk_bf16_f32 v78, v60, v61
    v_cvt_pk_bf16_f32 v79, v62, v63
    buffer_store_dwordx4 v[76:79], v88, s[16:19], s57 offen sc1
    s_waitcnt lgkmcnt(4)
    v_mfma_f32_32x32x16_bf16 v[16:31], v[108:111], v[172:175], v[16:31]
    ds_read_b64_tr_b16 v[104:105], v7 offset:28672
    ds_read_b64_tr_b16 v[106:107], v7 offset:29184
    s_waitcnt lgkmcnt(4)
    v_mfma_f32_32x32x16_bf16 v[16:31], v[248:251], v[176:179], v[16:31]
    ds_read_b64_tr_b16 v[108:109], v7 offset:30720
    ds_read_b64_tr_b16 v[110:111], v7 offset:31232
    s_waitcnt lgkmcnt(4)
    v_mfma_f32_32x32x16_bf16 v[16:31], v[252:255], v[180:183], v[16:31]
    ds_read_b64_tr_b16 v[248:249], v7 offset:32768
    ds_read_b64_tr_b16 v[250:251], v7 offset:33280
    s_waitcnt lgkmcnt(4)
    v_mfma_f32_32x32x16_bf16 v[16:31], v[104:107], v[184:187], v[16:31]
    ds_read_b64_tr_b16 v[252:253], v7 offset:34816
    ds_read_b64_tr_b16 v[254:255], v7 offset:35328
    s_waitcnt lgkmcnt(4)
    v_mfma_f32_32x32x16_bf16 v[16:31], v[108:111], v[188:191], v[16:31]
    ds_read_b64_tr_b16 v[104:105], v7 offset:36864
    ds_read_b64_tr_b16 v[106:107], v7 offset:37376
    s_waitcnt lgkmcnt(4)
    v_mfma_f32_32x32x16_bf16 v[16:31], v[248:251], v[192:195], v[16:31]
    ds_read_b64_tr_b16 v[108:109], v7 offset:38912
    ds_read_b64_tr_b16 v[110:111], v7 offset:39424
    s_waitcnt lgkmcnt(4)
    v_mfma_f32_32x32x16_bf16 v[16:31], v[252:255], v[196:199], v[16:31]
    ds_read_b64_tr_b16 v[248:249], v7 offset:40960
    ds_read_b64_tr_b16 v[250:251], v7 offset:41472
    s_waitcnt lgkmcnt(4)
    v_mfma_f32_32x32x16_bf16 v[16:31], v[104:107], v[200:203], v[16:31]
    ds_read_b64_tr_b16 v[252:253], v7 offset:43008
    ds_read_b64_tr_b16 v[254:255], v7 offset:43520
    s_waitcnt lgkmcnt(4)
    v_mfma_f32_32x32x16_bf16 v[16:31], v[108:111], v[204:207], v[16:31]
    ds_read_b64_tr_b16 v[104:105], v7 offset:45056
    ds_read_b64_tr_b16 v[106:107], v7 offset:45568
    s_waitcnt lgkmcnt(4)
    v_mfma_f32_32x32x16_bf16 v[16:31], v[248:251], v[208:211], v[16:31]
    ds_read_b64_tr_b16 v[108:109], v7 offset:47104
    ds_read_b64_tr_b16 v[110:111], v7 offset:47616
    s_waitcnt lgkmcnt(4)
    v_mfma_f32_32x32x16_bf16 v[16:31], v[252:255], v[212:215], v[16:31]
    ds_read_b64_tr_b16 v[248:249], v7 offset:49152
    ds_read_b64_tr_b16 v[250:251], v7 offset:49664
    s_waitcnt lgkmcnt(4)
    v_mfma_f32_32x32x16_bf16 v[16:31], v[104:107], v[216:219], v[16:31]
    ds_read_b64_tr_b16 v[252:253], v7 offset:51200
    ds_read_b64_tr_b16 v[254:255], v7 offset:51712
    s_waitcnt lgkmcnt(4)
    v_mfma_f32_32x32x16_bf16 v[16:31], v[108:111], v[220:223], v[16:31]
    ds_read_b64_tr_b16 v[104:105], v7 offset:53248
    ds_read_b64_tr_b16 v[106:107], v7 offset:53760
    s_waitcnt lgkmcnt(4)
    v_mfma_f32_32x32x16_bf16 v[16:31], v[248:251], v[224:227], v[16:31]
    ds_read_b64_tr_b16 v[108:109], v7 offset:55296
    ds_read_b64_tr_b16 v[110:111], v7 offset:55808
    s_waitcnt lgkmcnt(4)
    v_mfma_f32_32x32x16_bf16 v[16:31], v[252:255], v[228:231], v[16:31]
    s_waitcnt lgkmcnt(2)
    v_mfma_f32_32x32x16_bf16 v[16:31], v[104:107], v[232:235], v[16:31]
    s_waitcnt lgkmcnt(0)
    v_mfma_f32_32x32x16_bf16 v[16:31], v[108:111], v[236:239], v[16:31]
    s_nop 10
    v_mul_f32 v16, 0x3e8b97f6, v16
    v_mul_f32 v17, 0x3e8b97f6, v17
    v_mul_f32 v18, 0x3e8b97f6, v18
    v_mul_f32 v19, 0x3e8b97f6, v19
    v_mul_f32 v20, 0x3e8b97f6, v20
    v_mul_f32 v21, 0x3e8b97f6, v21
    v_mul_f32 v22, 0x3e8b97f6, v22
    v_mul_f32 v23, 0x3e8b97f6, v23
    v_cvt_pk_bf16_f32 v120, v16, v17
    v_cvt_pk_bf16_f32 v121, v18, v19
    v_cvt_pk_bf16_f32 v122, v20, v21
    v_cvt_pk_bf16_f32 v123, v22, v23
    buffer_store_dwordx4 v[120:123], v1, s[16:19], s54 offen offset:0 sc1
    v_mul_f32 v24, 0x3e8b97f6, v24
    v_mul_f32 v25, 0x3e8b97f6, v25
    v_mul_f32 v26, 0x3e8b97f6, v26
    v_mul_f32 v27, 0x3e8b97f6, v27
    v_mul_f32 v28, 0x3e8b97f6, v28
    v_mul_f32 v29, 0x3e8b97f6, v29
    v_mul_f32 v30, 0x3e8b97f6, v30
    v_mul_f32 v31, 0x3e8b97f6, v31
    v_cvt_pk_bf16_f32 v124, v24, v25
    v_cvt_pk_bf16_f32 v125, v26, v27
    v_cvt_pk_bf16_f32 v126, v28, v29
    v_cvt_pk_bf16_f32 v127, v30, v31
    buffer_store_dwordx4 v[124:127], v1, s[16:19], s54 offen offset:1024 sc1
    s_branch K_JOIN
K_IDLE:
    s_and_b32 s54, s2, 7
    s_bfe_u32 s69, s2, 0x20003
    s_lshr_b32 s50, s2, 5
    s_lshl_b32 s49, s54, 2
    s_add_u32 s49, s49, s69
    s_lshl_b32 s68, s50, 3
    s_add_u32 s68, s68, s54
    s_and_b32 s51, s49, 15
    s_mov_b32 s28, s78
    s_mov_b32 s29, s79
    s_mov_b32 s30, 401408
    s_mov_b32 s31, 0x00020000
    s_mov_b32 s32, s80
    s_mov_b32 s33, s81
    s_mov_b32 s34, 401408
    s_mov_b32 s35, 0x00020000
    s_mov_b32 s36, s82
    s_mov_b32 s37, s83
    s_mov_b32 s38, 896
    s_mov_b32 s39, 0x00020000
    s_mov_b32 s40, s84
    s_mov_b32 s41, s85
    s_mov_b32 s42, 1835008
    s_mov_b32 s43, 0x00020000
    s_mov_b32 s16, s90
    s_mov_b32 s17, s91
    s_mov_b32 s18, 11010048
    s_mov_b32 s19, 0x00020000
    s_add_u32 s24, s90, 11534336
    s_addc_u32 s25, s91, 0
    s_mov_b32 s26, 65792
    s_mov_b32 s27, 0x00020000
    s_load_dwordx2 s[74:75], s[24:25], 65536
    s_add_u32 s20, s90, 12582912
    s_addc_u32 s21, s91, 0
    s_mov_b32 s22, 4194304
    s_mov_b32 s23, 0x00020000
    s_and_b32 s54, s48, 1
    s_lshl_b32 s54, s54, 2
    v_lshrrev_b32 v80, 4, v0
    v_mul_u32_u24 v81, 896, v80
    v_or_b32 v80, s54, v80
    v_bfe_u32 v82, v0, 1, 3
    v_xor_b32 v80, v80, v82
    v_lshl_add_u32 v81, v80, 5, v81
    v_and_b32 v80, 1, v0
    v_lshl_add_u32 v12, v80, 4, v81
    s_mul_i32 s4, s48, 3584
    s_lshl_b32 s54, s69, 8
    s_add_u32 s4, s4, s54
    s_lshl_b32 s5, s48, 10
    v_lshrrev_b32 v80, 4, v0
    v_mul_u32_u24 v81, 896, v80
    v_bfe_u32 v82, v0, 1, 3
    v_xor_b32 v80, v80, v82
    v_and_b32 v82, 1, v0
    v_lshl_add_u32 v81, v82, 4, v81
    v_lshl_add_u32 v116, v80, 5, v81
    v_xor_b32 v80, 4, v80
    v_lshl_add_u32 v80, v80, 5, v81
    v_add_u32 v117, 2560, v80
    v_add_u32 v118, 5120, v116
    v_add_u32 v119, 7680, v80
    s_mul_i32 s6, s48, 10752
    s_add_u32 s6, s6, s4
    s_lshl_b32 s0, s48, 12
    s_add_u32 m0, s0, 131072
    s_add_u32 s7, s6, 0
    buffer_load_dwordx4 v116, s[28:31], s7 offen offset:0 lds
    buffer_load_dwordx4 v117, s[28:31], s7 offen offset:1024 lds
    buffer_load_dwordx4 v118, s[28:31], s7 offen offset:2048 lds
    buffer_load_dwordx4 v119, s[28:31], s7 offen offset:3072 lds
K_JOIN:
    v_lshrrev_b32 v85, 5, v0
    v_mul_u32_u24 v81, 6656, v85
    v_add_u32 v2, v81, v1
    v_mov_b32 v112, v1
    v_mov_b32 v113, v1
    v_mov_b32 v114, v2
    v_mov_b32 v115, v2
    s_mov_b64 s[12:13], s[16:17]
    s_mov_b64 s[14:15], s[18:19]
    v_bfe_u32 v80, v0, 2, 3
    v_xor_b32 v81, s48, v80
    v_lshl_add_u32 v80, v85, 4, v80
    v_lshlrev_b32 v80, 8, v80
    v_lshl_add_u32 v80, v81, 5, v80
    v_and_b32 v81, 3, v0
    v_lshl_add_u32 v4, v81, 3, v80
    v_cmp_gt_u32 vcc, 48, v0
    s_nop 0
    v_add_u32 v80, 2048, v4
    v_cndmask_b32 v5, v4, v80, vcc
    v_xor_b32 v6, 128, v4
    v_xor_b32 v7, 128, v5
    v_lshrrev_b32 v80, 4, v0
    v_lshlrev_b32 v80, 9, v80
    v_and_b32 v81, 15, v0
    v_lshl_add_u32 v9, v81, 4, v80
    v_mov_b32 v15, 0xdddddddd
    s_waitcnt lgkmcnt(0)
    s_add_u32 s74, s74, 0x9e3779b9
    s_add_u32 s75, s75, 0x7f4a7c15
    s_and_b32 s54, s2, 1
    s_mul_i32 s54, s54, 7
    s_add_u32 s54, s54, s52
    s_lshl_b32 s54, s54, 8
    s_add_u32 s54, s54, s53
    s_lshl_b32 s54, s54, 3
    v_lshlrev_b32 v80, 8, v0
    v_add_u32 v89, s54, v80
    s_lshl_b32 s54, s50, 4
    s_lshr_b32 s55, s49, 4
    s_add_u32 s54, s54, s55
    s_lshl_b32 s54, s54, 5
    s_add_u32 s54, s54, s51
    s_lshl_b32 s54, s54, 3
    s_add_u32 s54, s54, 32768
    v_lshl_add_u32 v3, v80, 1, s54
    v_and_b32 v80, 15, v0
    v_lshlrev_b32 v80, 3, v80
    v_bfe_u32 v81, v0, 4, 1
    s_lshl_b32 s54, s68, 9
    s_add_u32 s54, s54, 32768
    v_lshl_add_u32 v82, v81, 8, v80
    v_add_u32 v11, s54, v82
    s_mul_i32 s57, s55, 7
    s_mul_i32 s54, s51, 7
    s_lshr_b32 s54, s54, 1
    s_lshr_b32 s55, s54, 3
    s_add_u32 s56, s54, 3
    s_lshr_b32 s56, s56, 3
    s_sub_u32 s56, s56, s55
    s_add_u32 s55, s55, s57
    s_lshl_b32 s55, s55, 3
    s_add_u32 s55, s55, s50
    s_lshl_b32 s55, s55, 8
    v_and_b32 v81, s56, v81
    v_lshl_add_u32 v80, v81, 11, v80
    v_add_u32 v10, s55, v80
    s_mov_b32 s72, 0x0fffffff
    s_mov_b32 s73, 0x0fffffff
    s_lshr_b32 s55, s49, 4
    s_mul_i32 s55, s55, 5505024
    s_lshl_b32 s54, s54, 9
    s_add_u32 s70, s55, s54
    s_mul_i32 s56, s48, 86016
    s_add_u32 s65, s70, s56
    s_add_u32 s65, s65, 28672
    s_add_u32 s55, s55, s56
    s_mul_i32 s56, s51, 448
    s_add_u32 s66, s55, s56
    s_add_u32 s66, s66, 55296
    s_mov_b32 s62, 0
    s_mov_b32 s63, 32768
    s_mov_b32 s64, 65536
    s_lshr_b32 s54, s48, 2
    s_and_b32 s55, s48, 3
    s_lshl_b32 s55, s55, 1
    s_add_u32 s55, s55, s54
    s_lshl_b32 s53, s50, 3
    s_add_u32 s53, s53, s55
    s_lshl_b32 s54, s54, 14
    v_add_u32 v8, s54, v1
    v_mov_b32 v13, v8
    v_add_u32 v14, 32768, v8
    v_lshrrev_b32 v80, 4, v0
    v_min_u32 v80, 2, v80
    v_lshlrev_b32 v80, 15, v80
    v_bfe_u32 v81, v0, 2, 2
    v_lshl_add_u32 v80, v81, 9, v80
    v_and_b32 v81, 3, v0
    v_lshl_add_u32 v80, v81, 4, v80
    s_lshl_b32 s54, s48, 12
    s_add_u32 s54, s54, 2496
    v_add_u32 v100, s54, v80
    v_cmp_eq_u32 vcc, 0, v81
    s_nop 0
    v_mov_b32 v80, 0x3f803f80
    v_cndmask_b32 v232, 0, v80, vcc
    v_cndmask_b32 v233, 0, v80, vcc
    v_cndmask_b32 v234, 0, v80, vcc
    v_cndmask_b32 v235, 0, v80, vcc
    v_mov_b32 v48, 0
    v_mov_b32 v49, 0
    v_mov_b32 v50, 0
    v_mov_b32 v51, 0
    v_mov_b32 v52, 0
    v_mov_b32 v53, 0
    v_mov_b32 v54, 0
    v_mov_b32 v55, 0
    v_mov_b32 v56, 0
    v_mov_b32 v57, 0
    v_mov_b32 v58, 0
    v_mov_b32 v59, 0
    v_mov_b32 v60, 0
    v_mov_b32 v61, 0
    v_mov_b32 v62, 0
    v_mov_b32 v63, 0
    v_mov_b32 v40, 0
    v_mov_b32 v41, 0
    v_mov_b32 v42, 0
    v_mov_b32 v43, 0
    v_mov_b32 v44, 0
    v_mov_b32 v45, 0
    v_mov_b32 v46, 0
    v_mov_b32 v47, 0
    v_mov_b32 v76, 0
    v_mov_b32 v77, 0
    v_mov_b32 v78, 0
    v_mov_b32 v79, 0
    s_waitcnt vmcnt(0)
    s_barrier
    s_cmp_lg_u32 s48, 7
    s_cbranch_scc1 K_NF0
    s_cmp_ge_u32 s2, 224
    s_cbranch_scc1 K_NF0
    v_mov_b32 v80, s74
    v_mov_b32 v81, s75
    s_mov_b64 exec, 255
    buffer_store_dwordx2 v[80:81], v89, s[24:27], 0 offen offset:0 sc1
    s_mov_b64 exec, -1
K_NF0:
    ds_write_b128 v100, v[232:235]
    v_add_u32 v90, 131072, v4
    v_add_u32 v91, 131072, v5
    v_add_u32 v92, 131072, v6
    v_add_u32 v93, 131072, v7
    ds_read_b64_tr_b16 v[128:129], v90 offset:0
    ds_read_b64_tr_b16 v[130:131], v91 offset:0
    ds_read_b64_tr_b16 v[132:133], v92 offset:7168
    ds_read_b64_tr_b16 v[134:135], v93 offset:7168
    ds_read_b64_tr_b16 v[136:137], v90 offset:14336
    ds_read_b64_tr_b16 v[138:139], v91 offset:14336
    ds_read_b64_tr_b16 v[140:141], v92 offset:21504
    ds_read_b64_tr_b16 v[142:143], v93 offset:21504
    v_add_u32 v192, 98304, v4
    v_add_u32 v193, 98304, v5
    v_add_u32 v194, 98304, v6
    v_add_u32 v195, 98304, v7
    v_add_u32 v118, 13312, v118
    s_mov_b32 s61, s4
    s_add_u32 s3, s4, 172032
    s_add_u32 s71, s5, 98304
    s_add_u32 s4, s6, 200704
    v_mov_b32 v80, 0
    v_mov_b32 v81, 0
    v_mov_b32 v82, 0
    v_mov_b32 v83, 0
    v_mov_b32 v84, 0
    v_mov_b32 v85, 0
    v_mov_b32 v86, 0
    v_mov_b32 v87, 0
    v_mov_b32 v88, 0
    v_mov_b32 v89, 0
    v_mov_b32 v90, 0
    v_mov_b32 v91, 0
    v_mov_b32 v92, 0
    v_mov_b32 v93, 0
    v_mov_b32 v94, 0
    v_mov_b32 v95, 0
    s_cmp_lg_u32 s48, 7
    s_cbranch_scc1 K_P1_X
    s_mov_b32 s67, 100000
K_P1:
    buffer_load_dwordx2 v[66:67], v10, s[24:27], 0 offen offset:0 sc1
    s_sub_u32 s67, s67, 1
    s_cmp_eq_u32 s67, 0
    s_cbranch_scc1 K_P1_X
    s_waitcnt vmcnt(0)
    v_cmp_ne_u64 vcc, s[74:75], v[66:67]
    s_cbranch_vccnz K_P1
K_P1_X:
    s_barrier
    s_add_u32 m0, s62, s0
    s_nop 0
    buffer_load_dwordx4 v112, s[12:15], s65 offen sc1 lds
    buffer_load_dwordx4 v113, s[12:15], s65 offen offset:1024 sc1 lds
    s_add_u32 s65, s65, 688128
    s_mov_b64 exec, s[72:73]
    buffer_load_dwordx4 v114, s[12:15], s66 offen offset:2048 sc1 lds
    s_mov_b64 exec, -1
    s_add_u32 s66, s66, 13312
    s_mov_b64 exec, s[72:73]
    buffer_load_dwordx4 v115, s[12:15], s66 offen offset:3072 sc1 lds
    s_mov_b64 exec, -1
    s_add_u32 s66, s66, 674816
    s_xor_b32 s55, s53, 1
    s_mul_i32 s55, s55, 86016
    s_add_u32 s55, s55, s70
    s_mul_i32 s54, s53, 86016
    s_add_u32 s54, s54, s70
    buffer_load_dwordx4 v[104:107], v1, s[16:19], s55 offen sc1
    buffer_load_dwordx4 v[108:111], v1, s[16:19], s55 offen offset:1024 sc1
    buffer_load_dwordx4 v[120:123], v1, s[16:19], s54 offen sc1
    buffer_load_dwordx4 v[124:127], v1, s[16:19], s54 offen offset:1024 sc1
    s_bitcmp1_b32 s51, 0
    s_cselect_b32 vcc_lo, -1, 0
    s_cselect_b32 s55, 0, -1
    s_mov_b32 vcc_hi, 0
    s_mov_b32 s54, 0
    s_waitcnt vmcnt(0) lgkmcnt(0)
    v_cndmask_b32 v104, v104, v76, vcc
    v_cndmask_b32 v105, v105, v76, vcc
    v_cndmask_b32 v110, v110, v76, s[54:55]
    v_cndmask_b32 v111, v111, v76, s[54:55]
    v_cndmask_b32 v120, v120, v76, vcc
    v_cndmask_b32 v121, v121, v76, vcc
    v_cndmask_b32 v126, v126, v76, s[54:55]
    v_cndmask_b32 v127, v127, v76, s[54:55]
    s_barrier
    ds_read_b128 v[64:67], v13 offset:0
    ds_read_b128 v[68:71], v13 offset:1024
    ds_read_b128 v[72:75], v13 offset:2048
    s_waitcnt lgkmcnt(2)
    v_mfma_f32_32x32x16_bf16 v[16:31], v[64:67], v[104:107], 0
    s_waitcnt lgkmcnt(1)
    v_mfma_f32_32x32x16_bf16 v[16:31], v[68:71], v[108:111], v[16:31]
    s_lshl_b32 s54, s48, 12
    s_add_u32 s54, s54, 32768
    s_xor_b32 s55, s54, 16384
    s_lshr_b32 s56, s48, 2
    s_lshl_b32 s56, s56, 12
    s_add_u32 s56, s56, 155648
    s_xor_b32 s57, s56, 4096
    s_and_b32 s67, s48, 3
    s_cmp_eq_u32 s67, 3
    s_cselect_b32 s54, s56, s54
    s_cselect_b32 s55, s57, s55
    v_add_u32 v101, s54, v1
    v_add_u32 v100, s55, v1
    s_mov_b32 s67, 7
    s_setprio 1
    v_exp_f32 v16, v16
    v_exp_f32 v17, v17
    v_exp_f32 v18, v18
    v_smfmac_f32_32x32x32_bf16 v[48:63], v[76:79], v[40:47], v15
    ds_read_b128 v[76:79], v13 offset:3072
    s_add_u32 m0, s63, s0
    s_nop 0
    buffer_load_dwordx4 v112, s[12:15], s65 offen sc1 lds
    v_exp_f32 v19, v19
    v_exp_f32 v20, v20
    v_exp_f32 v21, v21
    v_exp_f32 v22, v22
    v_mfma_f32_32x32x16_bf16 v[32:47], v[64:67], v[120:123], 0
    ds_read_b128 v[64:67], v13 offset:4096
    buffer_load_dwordx4 v113, s[12:15], s65 offen offset:1024 sc1 lds
    s_add_u32 s65, s65, 688128
    v_exp_f32 v23, v23
    v_exp_f32 v24, v24
    v_exp_f32 v25, v25
    v_mfma_f32_32x32x16_bf16 v[32:47], v[68:71], v[124:127], v[32:47]
    ds_read_b128 v[68:71], v13 offset:5120
    v_exp_f32 v26, v26
    v_exp_f32 v27, v27
    v_exp_f32 v28, v28
    s_waitcnt lgkmcnt(3)
    v_smfmac_f32_32x32x32_bf16 v[80:95], v[72:75], v[16:23], v15
    s_mov_b64 exec, s[72:73]
    buffer_load_dwordx4 v114, s[12:15], s66 offen offset:2048 sc1 lds
    s_mov_b64 exec, -1
    s_add_u32 s66, s66, 13312
    v_exp_f32 v29, v29
    v_exp_f32 v30, v30
    v_exp_f32 v31, v31
    s_waitcnt lgkmcnt(0)
    s_setprio 0
    v_exp_f32 v32, v32
    v_exp_f32 v33, v33
    v_exp_f32 v34, v34
    v_smfmac_f32_32x32x32_bf16 v[80:95], v[76:79], v[24:31], v15
    s_mov_b64 exec, s[72:73]
    buffer_load_dwordx4 v115, s[12:15], s66 offen offset:3072 sc1 lds
    s_mov_b64 exec, -1
    s_add_u32 s66, s66, 674816
    v_exp_f32 v35, v35
    v_exp_f32 v36, v36
    v_exp_f32 v37, v37
    v_exp_f32 v38, v38
    v_mfma_f32_32x32x16_bf16 v[16:31], v[64:67], v[104:107], 0
    s_add_u32 m0, s71, 0
    s_add_u32 s7, s61, 100352
    buffer_load_dwordx4 v12, s[28:31], s7 offen lds
    v_exp_f32 v39, v39
    v_exp_f32 v40, v40
    v_exp_f32 v41, v41
    v_mfma_f32_32x32x16_bf16 v[16:31], v[68:71], v[108:111], v[16:31]
    v_exp_f32 v42, v42
    v_exp_f32 v43, v43
    v_exp_f32 v44, v44
    v_smfmac_f32_32x32x32_bf16 v[48:63], v[72:75], v[32:39], v15
    ds_read_b128 v[72:75], v13 offset:6144
    s_add_u32 m0, s71, 8192
    s_add_u32 s7, s61, 129024
    buffer_load_dwordx4 v12, s[28:31], s7 offen lds
    v_exp_f32 v45, v45
    v_exp_f32 v46, v46
    v_exp_f32 v47, v47
    s_setprio 1
    v_exp_f32 v16, v16
    v_exp_f32 v17, v17
    v_exp_f32 v18, v18
    v_smfmac_f32_32x32x32_bf16 v[48:63], v[76:79], v[40:47], v15
    ds_read_b128 v[76:79], v13 offset:7168
    s_add_u32 m0, s71, 16384
    s_add_u32 s7, s61, 157696
    buffer_load_dwordx4 v12, s[28:31], s7 offen lds
    v_exp_f32 v19, v19
    v_exp_f32 v20, v20
    v_exp_f32 v21, v21
    v_exp_f32 v22, v22
    v_mfma_f32_32x32x16_bf16 v[32:47], v[64:67], v[120:123], 0
    ds_read_b128 v[64:67], v13 offset:8192
    s_add_u32 m0, s71, 24576
    s_add_u32 s7, s61, 186368
    buffer_load_dwordx4 v12, s[28:31], s7 offen lds
    v_exp_f32 v23, v23
    v_exp_f32 v24, v24
    v_exp_f32 v25, v25
    v_mfma_f32_32x32x16_bf16 v[32:47], v[68:71], v[124:127], v[32:47]
    ds_read_b128 v[68:71], v13 offset:9216
    v_exp_f32 v26, v26
    v_exp_f32 v27, v27
    v_exp_f32 v28, v28
    s_waitcnt lgkmcnt(3)
    v_smfmac_f32_32x32x32_bf16 v[80:95], v[72:75], v[16:23], v15
    s_add_u32 m0, s71, 32768
    s_add_u32 s7, s61, 215040
    buffer_load_dwordx4 v12, s[28:31], s7 offen lds
    v_exp_f32 v29, v29
    v_exp_f32 v30, v30
    v_exp_f32 v31, v31
    s_waitcnt lgkmcnt(0)
    s_setprio 0
    v_exp_f32 v32, v32
    v_exp_f32 v33, v33
    v_exp_f32 v34, v34
    v_smfmac_f32_32x32x32_bf16 v[80:95], v[76:79], v[24:31], v15
    s_add_u32 m0, s71, 40960
    s_add_u32 s7, s61, 243712
    buffer_load_dwordx4 v12, s[28:31], s7 offen lds
    v_exp_f32 v35, v35
    v_exp_f32 v36, v36
    v_exp_f32 v37, v37
    v_exp_f32 v38, v38
    v_mfma_f32_32x32x16_bf16 v[16:31], v[64:67], v[104:107], 0
    s_add_u32 m0, s71, 49152
    s_add_u32 s7, s61, 272384
    buffer_load_dwordx4 v12, s[28:31], s7 offen lds
    v_exp_f32 v39, v39
    v_exp_f32 v40, v40
    v_exp_f32 v41, v41
    v_mfma_f32_32x32x16_bf16 v[16:31], v[68:71], v[108:111], v[16:31]
    v_exp_f32 v42, v42
    v_exp_f32 v43, v43
    v_exp_f32 v44, v44
    v_smfmac_f32_32x32x32_bf16 v[48:63], v[72:75], v[32:39], v15
    ds_read_b128 v[72:75], v13 offset:10240
    v_exp_f32 v45, v45
    v_exp_f32 v46, v46
    v_exp_f32 v47, v47
    s_setprio 1
    v_exp_f32 v16, v16
    v_exp_f32 v17, v17
    v_exp_f32 v18, v18
    v_smfmac_f32_32x32x32_bf16 v[48:63], v[76:79], v[40:47], v15
    ds_read_b128 v[76:79], v13 offset:11264
    v_exp_f32 v19, v19
    v_exp_f32 v20, v20
    v_exp_f32 v21, v21
    v_exp_f32 v22, v22
    v_mfma_f32_32x32x16_bf16 v[32:47], v[64:67], v[120:123], 0
    ds_read_b128 v[64:67], v13 offset:12288
    v_exp_f32 v23, v23
    v_exp_f32 v24, v24
    v_exp_f32 v25, v25
    v_mfma_f32_32x32x16_bf16 v[32:47], v[68:71], v[124:127], v[32:47]
    ds_read_b128 v[68:71], v13 offset:13312
    v_exp_f32 v26, v26
    v_exp_f32 v27, v27
    v_exp_f32 v28, v28
    s_waitcnt lgkmcnt(3)
    v_smfmac_f32_32x32x32_bf16 v[80:95], v[72:75], v[16:23], v15
    v_exp_f32 v29, v29
    v_exp_f32 v30, v30
    v_exp_f32 v31, v31
    s_waitcnt lgkmcnt(0)
    s_setprio 0
    v_exp_f32 v32, v32
    v_exp_f32 v33, v33
    v_exp_f32 v34, v34
    v_smfmac_f32_32x32x32_bf16 v[80:95], v[76:79], v[24:31], v15
    v_exp_f32 v35, v35
    v_exp_f32 v36, v36
    v_exp_f32 v37, v37
    v_exp_f32 v38, v38
    v_mfma_f32_32x32x16_bf16 v[16:31], v[64:67], v[104:107], 0
    v_exp_f32 v39, v39
    v_exp_f32 v40, v40
    v_exp_f32 v41, v41
    v_mfma_f32_32x32x16_bf16 v[16:31], v[68:71], v[108:111], v[16:31]
    v_exp_f32 v42, v42
    v_exp_f32 v43, v43
    v_exp_f32 v44, v44
    v_smfmac_f32_32x32x32_bf16 v[48:63], v[72:75], v[32:39], v15
    ds_read_b128 v[72:75], v13 offset:14336
    v_exp_f32 v45, v45
    v_exp_f32 v46, v46
    v_exp_f32 v47, v47
    s_waitcnt vmcnt(7)
    s_barrier
    s_setprio 1
    v_exp_f32 v16, v16
    v_exp_f32 v17, v17
    v_exp_f32 v18, v18
    v_smfmac_f32_32x32x32_bf16 v[48:63], v[76:79], v[40:47], v15
    ds_read_b128 v[76:79], v13 offset:15360
    v_exp_f32 v19, v19
    v_exp_f32 v20, v20
    v_exp_f32 v21, v21
    v_exp_f32 v22, v22
    v_mfma_f32_32x32x16_bf16 v[32:47], v[64:67], v[120:123], 0
    ds_read_b128 v[64:67], v14 offset:0
    s_add_u32 m0, s64, s0
    s_nop 0
    buffer_load_dwordx4 v112, s[12:15], s65 offen sc1 lds
    v_exp_f32 v23, v23
    v_exp_f32 v24, v24
    v_exp_f32 v25, v25
    v_mfma_f32_32x32x16_bf16 v[32:47], v[68:71], v[124:127], v[32:47]
    ds_read_b128 v[68:71], v14 offset:1024
    v_exp_f32 v26, v26
    v_exp_f32 v27, v27
    v_exp_f32 v28, v28
    s_waitcnt lgkmcnt(3)
    v_smfmac_f32_32x32x32_bf16 v[80:95], v[72:75], v[16:23], v15
    buffer_load_dwordx4 v113, s[12:15], s65 offen offset:1024 sc1 lds
    s_add_u32 s65, s65, 688128
    v_exp_f32 v29, v29
    v_exp_f32 v30, v30
    v_exp_f32 v31, v31
    s_waitcnt lgkmcnt(0)
    s_setprio 0
    v_exp_f32 v32, v32
    v_exp_f32 v33, v33
    v_exp_f32 v34, v34
    v_smfmac_f32_32x32x32_bf16 v[80:95], v[76:79], v[24:31], v15
    v_exp_f32 v35, v35
    v_exp_f32 v36, v36
    v_exp_f32 v37, v37
    v_exp_f32 v38, v38
    v_mfma_f32_32x32x16_bf16 v[16:31], v[64:67], v[104:107], 0
    s_mov_b64 exec, s[72:73]
    buffer_load_dwordx4 v114, s[12:15], s66 offen offset:2048 sc1 lds
    s_mov_b64 exec, -1
    s_add_u32 s66, s66, 13312
    v_exp_f32 v39, v39
    v_exp_f32 v40, v40
    v_exp_f32 v41, v41
    v_mfma_f32_32x32x16_bf16 v[16:31], v[68:71], v[108:111], v[16:31]
    v_exp_f32 v42, v42
    v_exp_f32 v43, v43
    v_exp_f32 v44, v44
    v_smfmac_f32_32x32x32_bf16 v[48:63], v[72:75], v[32:39], v15
    ds_read_b128 v[72:75], v14 offset:2048
    s_mov_b64 exec, s[72:73]
    buffer_load_dwordx4 v115, s[12:15], s66 offen offset:3072 sc1 lds
    s_mov_b64 exec, -1
    s_add_u32 s66, s66, 674816
    v_exp_f32 v45, v45
    v_exp_f32 v46, v46
    v_exp_f32 v47, v47
    s_waitcnt vmcnt(4)
    s_barrier
    ds_read_b64_tr_b16 v[144:145], v192 offset:0
    ds_read_b64_tr_b16 v[146:147], v193 offset:0
    ds_read_b64_tr_b16 v[148:149], v194 offset:7168
    ds_read_b64_tr_b16 v[150:151], v195 offset:7168
    ds_read_b64_tr_b16 v[152:153], v192 offset:14336
    ds_read_b64_tr_b16 v[154:155], v193 offset:14336
    ds_read_b64_tr_b16 v[156:157], v194 offset:21504
    ds_read_b64_tr_b16 v[158:159], v195 offset:21504
    ds_read_b64_tr_b16 v[160:161], v192 offset:28672
    ds_read_b64_tr_b16 v[162:163], v193 offset:28672
    ds_read_b64_tr_b16 v[164:165], v194 offset:35840
    ds_read_b64_tr_b16 v[166:167], v195 offset:35840
    ds_read_b64_tr_b16 v[168:169], v192 offset:43008
    ds_read_b64_tr_b16 v[170:171], v193 offset:43008
    ds_read_b64_tr_b16 v[172:173], v194 offset:50176
    ds_read_b64_tr_b16 v[174:175], v195 offset:50176
    s_mov_b32 s54, s62
    s_mov_b32 s62, s63
    s_mov_b32 s63, s64
    s_mov_b32 s64, s54
    v_mov_b32 v13, v14
    v_add_u32 v14, s63, v8
    s_add_u32 s61, s61, 301056
    .p2align 6
K_LOOP:
    s_setprio 1
    v_exp_f32 v16, v16
    v_exp_f32 v17, v17
    v_exp_f32 v18, v18
    v_smfmac_f32_32x32x32_bf16 v[48:63], v[76:79], v[40:47], v15
    ds_read_b128 v[76:79], v13 offset:3072
    v_exp_f32 v19, v19
    v_exp_f32 v20, v20
    v_exp_f32 v21, v21
    v_exp_f32 v22, v22
    v_mfma_f32_32x32x16_bf16 v[32:47], v[64:67], v[120:123], 0
    ds_read_b128 v[64:67], v13 offset:4096
    v_exp_f32 v23, v23
    v_exp_f32 v24, v24
    v_exp_f32 v25, v25
    v_mfma_f32_32x32x16_bf16 v[32:47], v[68:71], v[124:127], v[32:47]
    ds_read_b128 v[68:71], v13 offset:5120
    v_exp_f32 v26, v26
    v_exp_f32 v27, v27
    v_exp_f32 v28, v28
    s_waitcnt lgkmcnt(3)
    v_smfmac_f32_32x32x32_bf16 v[80:95], v[72:75], v[16:23], v15
    v_exp_f32 v29, v29
    v_exp_f32 v30, v30
    v_exp_f32 v31, v31
    s_waitcnt lgkmcnt(0)
    s_setprio 0
    v_exp_f32 v32, v32
    v_exp_f32 v33, v33
    v_exp_f32 v34, v34
    v_smfmac_f32_32x32x32_bf16 v[80:95], v[76:79], v[24:31], v15
    v_exp_f32 v35, v35
    v_exp_f32 v36, v36
    v_exp_f32 v37, v37
    v_exp_f32 v38, v38
    v_mfma_f32_32x32x16_bf16 v[16:31], v[64:67], v[104:107], 0
    v_exp_f32 v39, v39
    v_exp_f32 v40, v40
    v_exp_f32 v41, v41
    v_mfma_f32_32x32x16_bf16 v[16:31], v[68:71], v[108:111], v[16:31]
    v_exp_f32 v42, v42
    v_exp_f32 v43, v43
    v_exp_f32 v44, v44
    v_smfmac_f32_32x32x32_bf16 v[48:63], v[72:75], v[32:39], v15
    ds_read_b128 v[72:75], v13 offset:6144
    v_exp_f32 v45, v45
    v_exp_f32 v46, v46
    v_exp_f32 v47, v47
    s_setprio 1
    v_exp_f32 v16, v16
    v_exp_f32 v17, v17
    v_exp_f32 v18, v18
    v_smfmac_f32_32x32x32_bf16 v[48:63], v[76:79], v[40:47], v15
    ds_read_b128 v[76:79], v13 offset:7168
    v_exp_f32 v19, v19
    v_exp_f32 v20, v20
    v_exp_f32 v21, v21
    v_exp_f32 v22, v22
    v_mfma_f32_32x32x16_bf16 v[32:47], v[64:67], v[120:123], 0
    ds_read_b128 v[64:67], v13 offset:8192
    v_exp_f32 v23, v23
    v_exp_f32 v24, v24
    v_exp_f32 v25, v25
    v_mfma_f32_32x32x16_bf16 v[32:47], v[68:71], v[124:127], v[32:47]
    ds_read_b128 v[68:71], v13 offset:9216
    v_exp_f32 v26, v26
    v_exp_f32 v27, v27
    v_exp_f32 v28, v28
    s_waitcnt lgkmcnt(3)
    v_smfmac_f32_32x32x32_bf16 v[80:95], v[72:75], v[16:23], v15
    v_exp_f32 v29, v29
    v_exp_f32 v30, v30
    v_exp_f32 v31, v31
    s_waitcnt lgkmcnt(0)
    s_setprio 0
    v_exp_f32 v32, v32
    v_exp_f32 v33, v33
    v_exp_f32 v34, v34
    v_smfmac_f32_32x32x32_bf16 v[80:95], v[76:79], v[24:31], v15
    v_exp_f32 v35, v35
    v_exp_f32 v36, v36
    v_exp_f32 v37, v37
    v_exp_f32 v38, v38
    v_mfma_f32_32x32x16_bf16 v[16:31], v[64:67], v[104:107], 0
    v_exp_f32 v39, v39
    v_exp_f32 v40, v40
    v_exp_f32 v41, v41
    v_mfma_f32_32x32x16_bf16 v[16:31], v[68:71], v[108:111], v[16:31]
    v_exp_f32 v42, v42
    v_exp_f32 v43, v43
    v_exp_f32 v44, v44
    v_smfmac_f32_32x32x32_bf16 v[48:63], v[72:75], v[32:39], v15
    ds_read_b128 v[72:75], v13 offset:10240
    v_exp_f32 v45, v45
    v_exp_f32 v46, v46
    v_exp_f32 v47, v47
    s_setprio 1
    v_exp_f32 v16, v16
    v_exp_f32 v17, v17
    v_exp_f32 v18, v18
    v_smfmac_f32_32x32x32_bf16 v[48:63], v[76:79], v[40:47], v15
    ds_read_b128 v[76:79], v13 offset:11264
    v_exp_f32 v19, v19
    v_exp_f32 v20, v20
    v_exp_f32 v21, v21
    v_exp_f32 v22, v22
    v_mfma_f32_32x32x16_bf16 v[32:47], v[64:67], v[120:123], 0
    ds_read_b128 v[64:67], v13 offset:12288
    v_exp_f32 v23, v23
    v_exp_f32 v24, v24
    v_exp_f32 v25, v25
    v_mfma_f32_32x32x16_bf16 v[32:47], v[68:71], v[124:127], v[32:47]
    ds_read_b128 v[68:71], v13 offset:13312
    v_exp_f32 v26, v26
    v_exp_f32 v27, v27
    v_exp_f32 v28, v28
    s_waitcnt lgkmcnt(3)
    v_smfmac_f32_32x32x32_bf16 v[80:95], v[72:75], v[16:23], v15
    v_exp_f32 v29, v29
    v_exp_f32 v30, v30
    v_exp_f32 v31, v31
    s_waitcnt lgkmcnt(0)
    s_setprio 0
    v_exp_f32 v32, v32
    v_exp_f32 v33, v33
    v_exp_f32 v34, v34
    v_smfmac_f32_32x32x32_bf16 v[80:95], v[76:79], v[24:31], v15
    v_exp_f32 v35, v35
    v_exp_f32 v36, v36
    v_exp_f32 v37, v37
    v_exp_f32 v38, v38
    v_mfma_f32_32x32x16_bf16 v[16:31], v[64:67], v[104:107], 0
    v_exp_f32 v39, v39
    v_exp_f32 v40, v40
    v_exp_f32 v41, v41
    v_mfma_f32_32x32x16_bf16 v[16:31], v[68:71], v[108:111], v[16:31]
    v_exp_f32 v42, v42
    v_exp_f32 v43, v43
    v_exp_f32 v44, v44
    v_smfmac_f32_32x32x32_bf16 v[48:63], v[72:75], v[32:39], v15
    ds_read_b128 v[72:75], v13 offset:14336
    v_exp_f32 v45, v45
    v_exp_f32 v46, v46
    v_exp_f32 v47, v47
    s_waitcnt vmcnt(0)
    s_barrier
    s_setprio 1
    v_exp_f32 v16, v16
    v_exp_f32 v17, v17
    v_exp_f32 v18, v18
    v_smfmac_f32_32x32x32_bf16 v[48:63], v[76:79], v[40:47], v15
    ds_read_b128 v[76:79], v13 offset:15360
    s_mov_b32 m0, s71
    s_add_u32 s71, s71, 8192
    buffer_load_dwordx4 v12, s[28:31], s61 offen lds
    s_add_u32 s61, s61, 28672
    v_exp_f32 v19, v19
    v_exp_f32 v20, v20
    v_exp_f32 v21, v21
    v_exp_f32 v22, v22
    v_mfma_f32_32x32x16_bf16 v[32:47], v[64:67], v[120:123], 0
    ds_read_b128 v[64:67], v14 offset:0
    s_add_u32 m0, s64, s0
    s_nop 0
    buffer_load_dwordx4 v112, s[12:15], s65 offen sc1 lds
    v_exp_f32 v23, v23
    v_exp_f32 v24, v24
    v_exp_f32 v25, v25
    v_mfma_f32_32x32x16_bf16 v[32:47], v[68:71], v[124:127], v[32:47]
    ds_read_b128 v[68:71], v14 offset:1024
    v_exp_f32 v26, v26
    v_exp_f32 v27, v27
    v_exp_f32 v28, v28
    s_waitcnt lgkmcnt(3)
    v_smfmac_f32_32x32x32_bf16 v[80:95], v[72:75], v[16:23], v15
    buffer_load_dwordx4 v113, s[12:15], s65 offen offset:1024 sc1 lds
    s_add_u32 s65, s65, 688128
    v_exp_f32 v29, v29
    v_exp_f32 v30, v30
    v_exp_f32 v31, v31
    s_waitcnt lgkmcnt(0)
    s_setprio 0
    v_exp_f32 v32, v32
    v_exp_f32 v33, v33
    v_exp_f32 v34, v34
    v_smfmac_f32_32x32x32_bf16 v[80:95], v[76:79], v[24:31], v15
    v_exp_f32 v35, v35
    v_exp_f32 v36, v36
    v_exp_f32 v37, v37
    v_exp_f32 v38, v38
    v_mfma_f32_32x32x16_bf16 v[16:31], v[64:67], v[104:107], 0
    s_mov_b64 exec, s[72:73]
    buffer_load_dwordx4 v114, s[12:15], s66 offen offset:2048 sc1 lds
    s_mov_b64 exec, -1
    s_add_u32 s66, s66, 13312
    v_exp_f32 v39, v39
    v_exp_f32 v40, v40
    v_exp_f32 v41, v41
    v_mfma_f32_32x32x16_bf16 v[16:31], v[68:71], v[108:111], v[16:31]
    v_exp_f32 v42, v42
    v_exp_f32 v43, v43
    v_exp_f32 v44, v44
    v_smfmac_f32_32x32x32_bf16 v[48:63], v[72:75], v[32:39], v15
    ds_read_b128 v[72:75], v14 offset:2048
    s_mov_b64 exec, s[72:73]
    buffer_load_dwordx4 v115, s[12:15], s66 offen offset:3072 sc1 lds
    s_mov_b64 exec, -1
    s_add_u32 s66, s66, 674816
    v_exp_f32 v45, v45
    v_exp_f32 v46, v46
    v_exp_f32 v47, v47
    s_mov_b32 s54, s62
    s_mov_b32 s62, s63
    s_mov_b32 s63, s64
    s_mov_b32 s64, s54
    v_mov_b32 v13, v14
    v_add_u32 v14, s63, v8
    s_sub_u32 s67, s67, 1
    s_cmp_gt_u32 s67, 2
    s_cbranch_scc1 K_LOOP
    s_mov_b64 s[12:13], s[32:33]
    s_mov_b32 s14, s34
    s_mov_b64 s[72:73], -1
    s_mov_b32 s65, s4
    s_sub_u32 s66, s4, 13312
    s_add_u32 s4, s4, 100352
    v_mov_b32 v112, v116
    v_mov_b32 v113, v117
    v_mov_b32 v114, v118
    v_mov_b32 v115, v119
    s_cmp_eq_u32 s67, 0
    s_cbranch_scc1 K_EXIT
    s_lshl_b32 s54, s68, 3
    s_add_u32 s54, s54, s48
    s_mul_i32 s54, s54, 3584
    s_cmp_lg_u32 s67, 2
    s_cbranch_scc1 K_NG
    ds_read_b64_tr_b16 v[176:177], v192 offset:0
    ds_read_b64_tr_b16 v[178:179], v193 offset:0
    ds_read_b64_tr_b16 v[180:181], v194 offset:7168
    ds_read_b64_tr_b16 v[182:183], v195 offset:7168
    ds_read_b64_tr_b16 v[184:185], v192 offset:14336
    ds_read_b64_tr_b16 v[186:187], v193 offset:14336
    ds_read_b64_tr_b16 v[188:189], v194 offset:21504
    ds_read_b64_tr_b16 v[190:191], v195 offset:21504
    s_mov_b64 s[28:29], s[32:33]
    s_sub_u32 s61, s61, 444416
    s_sub_u32 s71, s71, 40960
    s_add_u32 m0, s71, 40960
    s_add_u32 s7, s61, 143360
    buffer_load_dwordx4 v12, s[32:35], s7 offen lds
    s_add_u32 m0, s71, 49152
    s_add_u32 s7, s61, 172032
    buffer_load_dwordx4 v12, s[32:35], s7 offen lds
    buffer_load_dwordx4 v[240:243], v1, s[8:11], s54 offen offset:0
    buffer_load_dwordx4 v[244:247], v1, s[8:11], s54 offen offset:896
    buffer_load_dwordx4 v[248:251], v1, s[8:11], s54 offen offset:1792
    s_branch K_LOOP
K_NG:
    s_add_u32 m0, s71, 24576
    s_add_u32 s7, s61, 86016
    buffer_load_dwordx4 v12, s[32:35], s7 offen lds
    s_mov_b32 m0, s71
    s_add_u32 s71, s71, 8192
    buffer_load_dwordx4 v12, s[28:31], s61 offen lds
    s_add_u32 s61, s61, 28672
    s_mov_b32 m0, s71
    s_add_u32 s71, s71, 8192
    buffer_load_dwordx4 v12, s[28:31], s61 offen lds
    s_add_u32 s61, s61, 28672
    buffer_load_dwordx4 v[252:255], v1, s[8:11], s54 offen offset:2688
    buffer_load_dwordx4 v[96:99], v1, s[36:39], 0 offen
    s_branch K_LOOP
K_EXIT:
    v_smfmac_f32_32x32x32_bf16 v[48:63], v[76:79], v[40:47], v15
    ds_write_b128 v101, v[80:83] offset:0
    ds_write_b128 v101, v[84:87] offset:1024
    ds_write_b128 v101, v[88:91] offset:2048
    ds_write_b128 v101, v[92:95] offset:3072
    s_waitcnt lgkmcnt(0)
    s_barrier
    ds_read_b128 v[28:31], v100 offset:3072
    ds_read_b128 v[16:19], v100 offset:0
    ds_read_b128 v[20:23], v100 offset:1024
    ds_read_b128 v[24:27], v100 offset:2048
    v_cmp_gt_u32 vcc, 32, v0
    s_lshl_b32 s57, s53, 5
    s_add_u32 s57, s57, s49
    s_lshl_b32 s57, s57, 11
    s_mov_b32 s67, 1
    s_waitcnt lgkmcnt(3)
    v_pk_add_f32 v[60:61], v[60:61], v[28:29]
    v_pk_add_f32 v[62:63], v[62:63], v[30:31]
    v_mov_b32 v80, v60
    v_mov_b32 v81, v60
    s_waitcnt lgkmcnt(2)
    v_pk_add_f32 v[48:49], v[48:49], v[16:17]
    v_pk_add_f32 v[50:51], v[50:51], v[18:19]
    v_permlane32_swap_b32 v81, v80
    s_waitcnt lgkmcnt(1)
    v_pk_add_f32 v[52:53], v[52:53], v[20:21]
    v_pk_add_f32 v[54:55], v[54:55], v[22:23]
    s_waitcnt lgkmcnt(0)
    v_pk_add_f32 v[56:57], v[56:57], v[24:25]
    v_pk_add_f32 v[58:59], v[58:59], v[26:27]
K_FINISH:
    v_rcp_f32 v82, v80
    s_nop 0
    v_pk_mul_f32 v[16:17], v[48:49], v[82:83] op_sel_hi:[1,0]
    v_pk_mul_f32 v[18:19], v[50:51], v[82:83] op_sel_hi:[1,0]
    v_pk_mul_f32 v[20:21], v[52:53], v[82:83] op_sel_hi:[1,0]
    v_pk_mul_f32 v[22:23], v[54:55], v[82:83] op_sel_hi:[1,0]
    v_cvt_pk_bf16_f32 v64, v16, v17
    v_cvt_pk_bf16_f32 v65, v18, v19
    v_cvt_pk_bf16_f32 v66, v20, v21
    v_cvt_pk_bf16_f32 v67, v22, v23
    buffer_store_dwordx4 v[64:67], v1, s[20:23], s57 offen offset:0 sc1
    v_pk_mul_f32 v[24:25], v[56:57], v[82:83] op_sel_hi:[1,0]
    v_pk_mul_f32 v[26:27], v[58:59], v[82:83] op_sel_hi:[1,0]
    v_pk_mul_f32 v[28:29], v[60:61], v[82:83] op_sel_hi:[1,0]
    v_pk_mul_f32 v[30:31], v[62:63], v[82:83] op_sel_hi:[1,0]
    v_cvt_pk_bf16_f32 v68, v24, v25
    v_cvt_pk_bf16_f32 v69, v26, v27
    v_cvt_pk_bf16_f32 v70, v28, v29
    v_cvt_pk_bf16_f32 v71, v30, v31
    v_cndmask_b32 v70, 0, v70, vcc
    v_cndmask_b32 v71, 0, v71, vcc
    buffer_store_dwordx4 v[68:71], v1, s[20:23], s57 offen offset:1024 sc1
    v_pk_add_f32 v[48:49], v[48:49], v[50:51]
    v_pk_add_f32 v[48:49], v[48:49], v[52:53]
    v_pk_add_f32 v[48:49], v[48:49], v[54:55]
    v_pk_add_f32 v[48:49], v[48:49], v[56:57]
    v_pk_add_f32 v[48:49], v[48:49], v[58:59]
    v_pk_add_f32 v[48:49], v[48:49], v[60:61]
    v_pk_add_f32 v[48:49], v[48:49], v[62:63]
    s_mov_b32 s54, 0x7f800000
    s_mov_b32 s55, 0x53800000
    s_mov_b32 s56, 0x33800000
    v_add_f32 v48, v48, v49
    v_cmp_ge_f32 s[64:65], s55, v80
    v_cmp_le_f32 vcc, s56, v80
    v_cmp_gt_f32 s[62:63], s54, abs(v48)
    s_nop 1
    s_and_b64 s[64:65], s[64:65], vcc
    s_and_b64 s[62:63], s[62:63], s[64:65]
    s_cmp_eq_u64 s[62:63], -1
    s_cselect_b32 s67, 0, s67
    s_cmp_lg_u32 s67, 0
    s_cbranch_scc1 K_FALLBACK
    v_mov_b32 v80, 0
    v_dot2_f32_bf16 v80, v240, v96, v80
    v_dot2_f32_bf16 v80, v241, v97, v80
    v_dot2_f32_bf16 v80, v242, v98, v80
    v_dot2_f32_bf16 v80, v243, v99, v80
    v_mov_b32 v81, 0
    v_dot2_f32_bf16 v81, v244, v96, v81
    v_dot2_f32_bf16 v81, v245, v97, v81
    v_dot2_f32_bf16 v81, v246, v98, v81
    v_dot2_f32_bf16 v81, v247, v99, v81
    v_mov_b32 v82, 0
    v_dot2_f32_bf16 v82, v248, v96, v82
    v_dot2_f32_bf16 v82, v249, v97, v82
    v_dot2_f32_bf16 v82, v250, v98, v82
    v_dot2_f32_bf16 v82, v251, v99, v82
    v_mov_b32 v83, 0
    v_dot2_f32_bf16 v83, v252, v96, v83
    v_dot2_f32_bf16 v83, v253, v97, v83
    v_dot2_f32_bf16 v83, v254, v98, v83
    v_dot2_f32_bf16 v83, v255, v99, v83
    s_nop 3
    v_add_f32_dpp v80, v80, v80 row_shr:1 row_mask:0xf bank_mask:0xf bound_ctrl:0
    v_add_f32_dpp v81, v81, v81 row_shr:1 row_mask:0xf bank_mask:0xf bound_ctrl:0
    v_add_f32_dpp v82, v82, v82 row_shr:1 row_mask:0xf bank_mask:0xf bound_ctrl:0
    v_add_f32_dpp v83, v83, v83 row_shr:1 row_mask:0xf bank_mask:0xf bound_ctrl:0
    v_add_f32_dpp v80, v80, v80 row_shr:2 row_mask:0xf bank_mask:0xf bound_ctrl:0
    v_add_f32_dpp v81, v81, v81 row_shr:2 row_mask:0xf bank_mask:0xf bound_ctrl:0
    v_add_f32_dpp v82, v82, v82 row_shr:2 row_mask:0xf bank_mask:0xf bound_ctrl:0
    v_add_f32_dpp v83, v83, v83 row_shr:2 row_mask:0xf bank_mask:0xf bound_ctrl:0
    v_add_f32_dpp v80, v80, v80 row_shr:4 row_mask:0xf bank_mask:0xf bound_ctrl:0
    v_add_f32_dpp v81, v81, v81 row_shr:4 row_mask:0xf bank_mask:0xf bound_ctrl:0
    v_add_f32_dpp v82, v82, v82 row_shr:4 row_mask:0xf bank_mask:0xf bound_ctrl:0
    v_add_f32_dpp v83, v83, v83 row_shr:4 row_mask:0xf bank_mask:0xf bound_ctrl:0
    v_add_f32_dpp v80, v80, v80 row_shr:8 row_mask:0xf bank_mask:0xf bound_ctrl:0
    v_add_f32_dpp v81, v81, v81 row_shr:8 row_mask:0xf bank_mask:0xf bound_ctrl:0
    v_add_f32_dpp v82, v82, v82 row_shr:8 row_mask:0xf bank_mask:0xf bound_ctrl:0
    v_add_f32_dpp v83, v83, v83 row_shr:8 row_mask:0xf bank_mask:0xf bound_ctrl:0
    v_add_f32_dpp v80, v80, v80 row_bcast:15 row_mask:0xa bank_mask:0xf
    v_add_f32_dpp v81, v81, v81 row_bcast:15 row_mask:0xa bank_mask:0xf
    v_add_f32_dpp v82, v82, v82 row_bcast:15 row_mask:0xa bank_mask:0xf
    v_add_f32_dpp v83, v83, v83 row_bcast:15 row_mask:0xa bank_mask:0xf
    v_add_f32_dpp v80, v80, v80 row_bcast:31 row_mask:0xc bank_mask:0xf
    v_add_f32_dpp v81, v81, v81 row_bcast:31 row_mask:0xc bank_mask:0xf
    v_add_f32_dpp v82, v82, v82 row_bcast:31 row_mask:0xc bank_mask:0xf
    v_add_f32_dpp v83, v83, v83 row_bcast:31 row_mask:0xc bank_mask:0xf
    v_mul_f32 v80, 0xbfb8aa3b, v80
    v_mul_f32 v81, 0xbfb8aa3b, v81
    v_mul_f32 v82, 0xbfb8aa3b, v82
    v_mul_f32 v83, 0xbfb8aa3b, v83
    v_exp_f32 v80, v80
    v_exp_f32 v81, v81
    v_exp_f32 v82, v82
    v_exp_f32 v83, v83
    v_add_f32 v80, 1.0, v80
    v_add_f32 v81, 1.0, v81
    v_add_f32 v82, 1.0, v82
    v_add_f32 v83, 1.0, v83
    v_rcp_f32 v84, v80
    v_rcp_f32 v85, v81
    v_rcp_f32 v86, v82
    v_rcp_f32 v87, v83
    v_and_b32 v80, 15, v0
    v_lshlrev_b32 v32, 2, v80
    v_add_u32 v32, 155648, v32
    v_mul_u32_u24 v80, 896, v80
    v_lshrrev_b32 v81, 4, v0
    v_lshl_add_u32 v34, v81, 3, v80
    v_subrev_u32 v118, 13312, v118
    v_add_u32 v9, 65536, v9
    s_waitcnt vmcnt(0)
    s_barrier
    s_cmp_lg_u32 s48, 7
    s_cbranch_scc1 K_NF2
    v_mov_b32 v80, s74
    v_mov_b32 v81, s75
    s_mov_b64 exec, 255
    buffer_store_dwordx2 v[80:81], v3, s[24:27], 0 offen offset:0 sc1
    s_mov_b64 exec, -1
K_NF2:
    s_lshl_b32 s54, s48, 4
    s_add_u32 s54, s54, 155648
    v_mov_b32 v88, s54
    s_mov_b32 exec_lo, 0
    s_mov_b32 exec_hi, 0x80000000
    ds_write_b128 v88, v[84:87]
    s_mov_b64 exec, -1
    v_add_u32 v90, 0, v4
    v_add_u32 v91, 0, v5
    v_add_u32 v92, 0, v6
    v_add_u32 v93, 0, v7
    ds_read_b64_tr_b16 v[240:241], v90 offset:0
    ds_read_b64_tr_b16 v[242:243], v91 offset:0
    ds_read_b64_tr_b16 v[244:245], v92 offset:7168
    ds_read_b64_tr_b16 v[246:247], v93 offset:7168
    ds_read_b64_tr_b16 v[248:249], v90 offset:14336
    ds_read_b64_tr_b16 v[250:251], v91 offset:14336
    ds_read_b64_tr_b16 v[252:253], v92 offset:21504
    ds_read_b64_tr_b16 v[254:255], v93 offset:21504
    v_add_u32 v90, 65536, v4
    v_add_u32 v91, 65536, v5
    v_add_u32 v92, 65536, v6
    v_add_u32 v93, 65536, v7
    ds_read_b64_tr_b16 v[224:225], v90 offset:0
    ds_read_b64_tr_b16 v[226:227], v91 offset:0
    ds_read_b64_tr_b16 v[228:229], v92 offset:7168
    ds_read_b64_tr_b16 v[230:231], v93 offset:7168
    ds_read_b64_tr_b16 v[232:233], v90 offset:14336
    ds_read_b64_tr_b16 v[234:235], v91 offset:14336
    ds_read_b64_tr_b16 v[236:237], v92 offset:21504
    ds_read_b64_tr_b16 v[238:239], v93 offset:21504
    v_add_u32 v90, 98304, v4
    v_add_u32 v91, 98304, v5
    v_add_u32 v92, 98304, v6
    v_add_u32 v93, 98304, v7
    ds_read_b64_tr_b16 v[192:193], v90 offset:0
    ds_read_b64_tr_b16 v[194:195], v91 offset:0
    ds_read_b64_tr_b16 v[196:197], v92 offset:7168
    ds_read_b64_tr_b16 v[198:199], v93 offset:7168
    ds_read_b64_tr_b16 v[200:201], v90 offset:14336
    ds_read_b64_tr_b16 v[202:203], v91 offset:14336
    ds_read_b64_tr_b16 v[204:205], v92 offset:21504
    ds_read_b64_tr_b16 v[206:207], v93 offset:21504
    ds_read_b64_tr_b16 v[208:209], v90 offset:28672
    ds_read_b64_tr_b16 v[210:211], v91 offset:28672
    ds_read_b64_tr_b16 v[212:213], v92 offset:35840
    ds_read_b64_tr_b16 v[214:215], v93 offset:35840
    ds_read_b64_tr_b16 v[216:217], v90 offset:43008
    ds_read_b64_tr_b16 v[218:219], v91 offset:43008
    ds_read_b64_tr_b16 v[220:221], v92 offset:50176
    ds_read_b64_tr_b16 v[222:223], v93 offset:50176
    s_cmp_lg_u32 s48, 7
    s_cbranch_scc1 K_P2_X
    s_mov_b32 s67, 100000
K_P2:
    buffer_load_dwordx2 v[82:83], v11, s[24:27], 0 offen offset:0 sc1
    s_sub_u32 s67, s67, 1
    s_cmp_eq_u32 s67, 0
    s_cbranch_scc1 K_P2_X
    s_waitcnt vmcnt(0)
    v_cmp_ne_u64 vcc, s[74:75], v[82:83]
    s_cbranch_vccnz K_P2
K_P2_X:
    s_waitcnt vmcnt(0) lgkmcnt(0)
    s_barrier
    s_lshl_b32 s55, s48, 10
    s_lshl_b32 s54, s68, 16
    s_add_u32 s54, s54, s55
    s_add_u32 m0, s55, 65536
    s_add_u32 s56, s54, 0
    buffer_load_dwordx4 v1, s[20:23], s56 offen sc1 lds
    s_add_u32 m0, s55, 73728
    s_add_u32 s56, s54, 8192
    buffer_load_dwordx4 v1, s[20:23], s56 offen sc1 lds
    s_add_u32 m0, s55, 81920
    s_add_u32 s56, s54, 16384
    buffer_load_dwordx4 v1, s[20:23], s56 offen sc1 lds
    s_add_u32 m0, s55, 90112
    s_add_u32 s56, s54, 24576
    buffer_load_dwordx4 v1, s[20:23], s56 offen sc1 lds
    s_add_u32 m0, s55, 98304
    s_add_u32 s56, s54, 32768
    buffer_load_dwordx4 v1, s[20:23], s56 offen sc1 lds
    s_add_u32 m0, s55, 106496
    s_add_u32 s56, s54, 40960
    buffer_load_dwordx4 v1, s[20:23], s56 offen sc1 lds
    s_add_u32 m0, s55, 114688
    s_add_u32 s56, s54, 49152
    buffer_load_dwordx4 v1, s[20:23], s56 offen sc1 lds
    s_add_u32 m0, s55, 122880
    s_add_u32 s56, s54, 57344
    buffer_load_dwordx4 v1, s[20:23], s56 offen sc1 lds
    s_mul_i32 s54, s68, 28672
    s_lshl_b32 s56, s69, 3
    s_add_u32 s56, s56, s48
    s_lshl_b32 s55, s56, 5
    s_add_u32 s54, s54, s55
    s_add_u32 s55, s54, 14336
    s_cmp_ge_u32 s56, 28
    s_cbranch_scc1 K_W7
    ds_read_b32 v33, v32 offset:64
    ds_read_b32 v32, v32
    s_waitcnt lgkmcnt(0)
    s_waitcnt vmcnt(7)
    s_barrier
    ds_read_b128 v[64:67], v9 offset:0
    ds_read_b128 v[68:71], v9 offset:256
    ds_read_b128 v[72:75], v9 offset:2048
    ds_read_b128 v[76:79], v9 offset:2304
    ds_read_b128 v[80:83], v9 offset:4096
    ds_read_b128 v[84:87], v9 offset:4352
    ds_read_b128 v[88:91], v9 offset:6144
    ds_read_b128 v[92:95], v9 offset:6400
    s_waitcnt vmcnt(6)
    s_barrier
    ds_read_b128 v[96:99], v9 offset:8192
    ds_read_b128 v[100:103], v9 offset:8448
    ds_read_b128 v[104:107], v9 offset:10240
    ds_read_b128 v[108:111], v9 offset:10496
    ds_read_b128 v[112:115], v9 offset:12288
    ds_read_b128 v[116:119], v9 offset:12544
    ds_read_b128 v[120:123], v9 offset:14336
    ds_read_b128 v[124:127], v9 offset:14592
    s_waitcnt lgkmcnt(15)
    v_mfma_f32_16x16x32_bf16 v[16:19], v[128:131], v[64:67], 0
    s_waitcnt lgkmcnt(14)
    v_mfma_f32_16x16x32_bf16 v[20:23], v[128:131], v[68:71], 0
    s_waitcnt lgkmcnt(13)
    v_mfma_f32_16x16x32_bf16 v[16:19], v[132:135], v[72:75], v[16:19]
    s_waitcnt lgkmcnt(12)
    v_mfma_f32_16x16x32_bf16 v[20:23], v[132:135], v[76:79], v[20:23]
    s_waitcnt lgkmcnt(11)
    v_mfma_f32_16x16x32_bf16 v[16:19], v[136:139], v[80:83], v[16:19]
    s_waitcnt lgkmcnt(10)
    v_mfma_f32_16x16x32_bf16 v[20:23], v[136:139], v[84:87], v[20:23]
    s_waitcnt lgkmcnt(9)
    v_mfma_f32_16x16x32_bf16 v[16:19], v[140:143], v[88:91], v[16:19]
    s_waitcnt lgkmcnt(8)
    v_mfma_f32_16x16x32_bf16 v[20:23], v[140:143], v[92:95], v[20:23]
    s_waitcnt vmcnt(5)
    s_barrier
    ds_read_b128 v[64:67], v9 offset:16384
    ds_read_b128 v[68:71], v9 offset:16640
    ds_read_b128 v[72:75], v9 offset:18432
    ds_read_b128 v[76:79], v9 offset:18688
    ds_read_b128 v[80:83], v9 offset:20480
    ds_read_b128 v[84:87], v9 offset:20736
    ds_read_b128 v[88:91], v9 offset:22528
    ds_read_b128 v[92:95], v9 offset:22784
    s_waitcnt lgkmcnt(15)
    v_mfma_f32_16x16x32_bf16 v[16:19], v[144:147], v[96:99], v[16:19]
    s_waitcnt lgkmcnt(14)
    v_mfma_f32_16x16x32_bf16 v[20:23], v[144:147], v[100:103], v[20:23]
    s_waitcnt lgkmcnt(13)
    v_mfma_f32_16x16x32_bf16 v[16:19], v[148:151], v[104:107], v[16:19]
    s_waitcnt lgkmcnt(12)
    v_mfma_f32_16x16x32_bf16 v[20:23], v[148:151], v[108:111], v[20:23]
    s_waitcnt lgkmcnt(11)
    v_mfma_f32_16x16x32_bf16 v[16:19], v[152:155], v[112:115], v[16:19]
    s_waitcnt lgkmcnt(10)
    v_mfma_f32_16x16x32_bf16 v[20:23], v[152:155], v[116:119], v[20:23]
    s_waitcnt lgkmcnt(9)
    v_mfma_f32_16x16x32_bf16 v[16:19], v[156:159], v[120:123], v[16:19]
    s_waitcnt lgkmcnt(8)
    v_mfma_f32_16x16x32_bf16 v[20:23], v[156:159], v[124:127], v[20:23]
    s_waitcnt vmcnt(4)
    s_barrier
    ds_read_b128 v[96:99], v9 offset:24576
    ds_read_b128 v[100:103], v9 offset:24832
    ds_read_b128 v[104:107], v9 offset:26624
    ds_read_b128 v[108:111], v9 offset:26880
    ds_read_b128 v[112:115], v9 offset:28672
    ds_read_b128 v[116:119], v9 offset:28928
    ds_read_b128 v[120:123], v9 offset:30720
    ds_read_b128 v[124:127], v9 offset:30976
    s_waitcnt lgkmcnt(15)
    v_mfma_f32_16x16x32_bf16 v[16:19], v[160:163], v[64:67], v[16:19]
    s_waitcnt lgkmcnt(14)
    v_mfma_f32_16x16x32_bf16 v[20:23], v[160:163], v[68:71], v[20:23]
    s_waitcnt lgkmcnt(13)
    v_mfma_f32_16x16x32_bf16 v[16:19], v[164:167], v[72:75], v[16:19]
    s_waitcnt lgkmcnt(12)
    v_mfma_f32_16x16x32_bf16 v[20:23], v[164:167], v[76:79], v[20:23]
    s_waitcnt lgkmcnt(11)
    v_mfma_f32_16x16x32_bf16 v[16:19], v[168:171], v[80:83], v[16:19]
    s_waitcnt lgkmcnt(10)
    v_mfma_f32_16x16x32_bf16 v[20:23], v[168:171], v[84:87], v[20:23]
    s_waitcnt lgkmcnt(9)
    v_mfma_f32_16x16x32_bf16 v[16:19], v[172:175], v[88:91], v[16:19]
    s_waitcnt lgkmcnt(8)
    v_mfma_f32_16x16x32_bf16 v[20:23], v[172:175], v[92:95], v[20:23]
    s_waitcnt vmcnt(3)
    s_barrier
    ds_read_b128 v[64:67], v9 offset:32768
    ds_read_b128 v[68:71], v9 offset:33024
    ds_read_b128 v[72:75], v9 offset:34816
    ds_read_b128 v[76:79], v9 offset:35072
    ds_read_b128 v[80:83], v9 offset:36864
    ds_read_b128 v[84:87], v9 offset:37120
    ds_read_b128 v[88:91], v9 offset:38912
    ds_read_b128 v[92:95], v9 offset:39168
    s_waitcnt lgkmcnt(15)
    v_mfma_f32_16x16x32_bf16 v[16:19], v[176:179], v[96:99], v[16:19]
    s_waitcnt lgkmcnt(14)
    v_mfma_f32_16x16x32_bf16 v[20:23], v[176:179], v[100:103], v[20:23]
    s_waitcnt lgkmcnt(13)
    v_mfma_f32_16x16x32_bf16 v[16:19], v[180:183], v[104:107], v[16:19]
    s_waitcnt lgkmcnt(12)
    v_mfma_f32_16x16x32_bf16 v[20:23], v[180:183], v[108:111], v[20:23]
    s_waitcnt lgkmcnt(11)
    v_mfma_f32_16x16x32_bf16 v[16:19], v[184:187], v[112:115], v[16:19]
    s_waitcnt lgkmcnt(10)
    v_mfma_f32_16x16x32_bf16 v[20:23], v[184:187], v[116:119], v[20:23]
    s_waitcnt lgkmcnt(9)
    v_mfma_f32_16x16x32_bf16 v[16:19], v[188:191], v[120:123], v[16:19]
    s_waitcnt lgkmcnt(8)
    v_mfma_f32_16x16x32_bf16 v[20:23], v[188:191], v[124:127], v[20:23]
    s_waitcnt vmcnt(2)
    s_barrier
    ds_read_b128 v[96:99], v9 offset:40960
    ds_read_b128 v[100:103], v9 offset:41216
    ds_read_b128 v[104:107], v9 offset:43008
    ds_read_b128 v[108:111], v9 offset:43264
    ds_read_b128 v[112:115], v9 offset:45056
    ds_read_b128 v[116:119], v9 offset:45312
    ds_read_b128 v[120:123], v9 offset:47104
    ds_read_b128 v[124:127], v9 offset:47360
    s_waitcnt lgkmcnt(15)
    v_mfma_f32_16x16x32_bf16 v[24:27], v[192:195], v[64:67], 0
    s_waitcnt lgkmcnt(14)
    v_mfma_f32_16x16x32_bf16 v[28:31], v[192:195], v[68:71], 0
    s_waitcnt lgkmcnt(13)
    v_mfma_f32_16x16x32_bf16 v[24:27], v[196:199], v[72:75], v[24:27]
    s_waitcnt lgkmcnt(12)
    v_mfma_f32_16x16x32_bf16 v[28:31], v[196:199], v[76:79], v[28:31]
    s_waitcnt lgkmcnt(11)
    v_mfma_f32_16x16x32_bf16 v[24:27], v[200:203], v[80:83], v[24:27]
    s_waitcnt lgkmcnt(10)
    v_mfma_f32_16x16x32_bf16 v[28:31], v[200:203], v[84:87], v[28:31]
    s_waitcnt lgkmcnt(9)
    v_mfma_f32_16x16x32_bf16 v[24:27], v[204:207], v[88:91], v[24:27]
    s_waitcnt lgkmcnt(8)
    v_mfma_f32_16x16x32_bf16 v[28:31], v[204:207], v[92:95], v[28:31]
    s_waitcnt vmcnt(1)
    s_barrier
    ds_read_b128 v[64:67], v9 offset:49152
    ds_read_b128 v[68:71], v9 offset:49408
    ds_read_b128 v[72:75], v9 offset:51200
    ds_read_b128 v[76:79], v9 offset:51456
    ds_read_b128 v[80:83], v9 offset:53248
    ds_read_b128 v[84:87], v9 offset:53504
    ds_read_b128 v[88:91], v9 offset:55296
    ds_read_b128 v[92:95], v9 offset:55552
    s_waitcnt lgkmcnt(15)
    v_mfma_f32_16x16x32_bf16 v[24:27], v[208:211], v[96:99], v[24:27]
    s_waitcnt lgkmcnt(14)
    v_mfma_f32_16x16x32_bf16 v[28:31], v[208:211], v[100:103], v[28:31]
    s_waitcnt lgkmcnt(13)
    v_mfma_f32_16x16x32_bf16 v[24:27], v[212:215], v[104:107], v[24:27]
    s_waitcnt lgkmcnt(12)
    v_mfma_f32_16x16x32_bf16 v[28:31], v[212:215], v[108:111], v[28:31]
    s_waitcnt lgkmcnt(11)
    v_mfma_f32_16x16x32_bf16 v[24:27], v[216:219], v[112:115], v[24:27]
    s_waitcnt lgkmcnt(10)
    v_mfma_f32_16x16x32_bf16 v[28:31], v[216:219], v[116:119], v[28:31]
    s_waitcnt lgkmcnt(9)
    v_mfma_f32_16x16x32_bf16 v[24:27], v[220:223], v[120:123], v[24:27]
    s_waitcnt lgkmcnt(8)
    v_mfma_f32_16x16x32_bf16 v[28:31], v[220:223], v[124:127], v[28:31]
    s_waitcnt vmcnt(0)
    s_barrier
    ds_read_b128 v[96:99], v9 offset:57344
    ds_read_b128 v[100:103], v9 offset:57600
    ds_read_b128 v[104:107], v9 offset:59392
    ds_read_b128 v[108:111], v9 offset:59648
    ds_read_b128 v[112:115], v9 offset:61440
    ds_read_b128 v[116:119], v9 offset:61696
    ds_read_b128 v[120:123], v9 offset:63488
    ds_read_b128 v[124:127], v9 offset:63744
    s_waitcnt lgkmcnt(15)
    v_mfma_f32_16x16x32_bf16 v[24:27], v[224:227], v[64:67], v[24:27]
    s_waitcnt lgkmcnt(14)
    v_mfma_f32_16x16x32_bf16 v[28:31], v[224:227], v[68:71], v[28:31]
    s_waitcnt lgkmcnt(13)
    v_mfma_f32_16x16x32_bf16 v[24:27], v[228:231], v[72:75], v[24:27]
    s_waitcnt lgkmcnt(12)
    v_mfma_f32_16x16x32_bf16 v[28:31], v[228:231], v[76:79], v[28:31]
    s_waitcnt lgkmcnt(11)
    v_mfma_f32_16x16x32_bf16 v[24:27], v[232:235], v[80:83], v[24:27]
    s_waitcnt lgkmcnt(10)
    v_mfma_f32_16x16x32_bf16 v[28:31], v[232:235], v[84:87], v[28:31]
    s_waitcnt lgkmcnt(9)
    v_mfma_f32_16x16x32_bf16 v[24:27], v[236:239], v[88:91], v[24:27]
    s_waitcnt lgkmcnt(8)
    v_mfma_f32_16x16x32_bf16 v[28:31], v[236:239], v[92:95], v[28:31]
    s_waitcnt lgkmcnt(7)
    v_mfma_f32_16x16x32_bf16 v[24:27], v[240:243], v[96:99], v[24:27]
    s_waitcnt lgkmcnt(6)
    v_mfma_f32_16x16x32_bf16 v[28:31], v[240:243], v[100:103], v[28:31]
    s_waitcnt lgkmcnt(5)
    v_mfma_f32_16x16x32_bf16 v[24:27], v[244:247], v[104:107], v[24:27]
    s_waitcnt lgkmcnt(4)
    v_mfma_f32_16x16x32_bf16 v[28:31], v[244:247], v[108:111], v[28:31]
    s_waitcnt lgkmcnt(3)
    v_mfma_f32_16x16x32_bf16 v[24:27], v[248:251], v[112:115], v[24:27]
    s_waitcnt lgkmcnt(2)
    v_mfma_f32_16x16x32_bf16 v[28:31], v[248:251], v[116:119], v[28:31]
    s_waitcnt lgkmcnt(1)
    v_mfma_f32_16x16x32_bf16 v[24:27], v[252:255], v[120:123], v[24:27]
    s_waitcnt lgkmcnt(0)
    v_mfma_f32_16x16x32_bf16 v[28:31], v[252:255], v[124:127], v[28:31]
    s_nop 7
    v_sub_f32 v16, v16, v24
    v_fma_f32 v16, v16, v32, v24
    v_sub_f32 v17, v17, v25
    v_fma_f32 v17, v17, v32, v25
    v_sub_f32 v18, v18, v26
    v_fma_f32 v18, v18, v32, v26
    v_sub_f32 v19, v19, v27
    v_fma_f32 v19, v19, v32, v27
    v_cvt_pk_bf16_f32 v36, v16, v17
    v_cvt_pk_bf16_f32 v37, v18, v19
    buffer_store_dwordx2 v[36:37], v34, s[40:43], s54 offen
    v_sub_f32 v20, v20, v28
    v_fma_f32 v20, v20, v33, v28
    v_sub_f32 v21, v21, v29
    v_fma_f32 v21, v21, v33, v29
    v_sub_f32 v22, v22, v30
    v_fma_f32 v22, v22, v33, v30
    v_sub_f32 v23, v23, v31
    v_fma_f32 v23, v23, v33, v31
    v_cvt_pk_bf16_f32 v38, v20, v21
    v_cvt_pk_bf16_f32 v39, v22, v23
    buffer_store_dwordx2 v[38:39], v34, s[40:43], s55 offen
K_DONE:
K_END:
    s_endpgm
K_W7:
    s_waitcnt vmcnt(7)
    s_barrier
    s_waitcnt vmcnt(6)
    s_barrier
    s_waitcnt vmcnt(5)
    s_barrier
    s_waitcnt vmcnt(4)
    s_barrier
    s_waitcnt vmcnt(3)
    s_barrier
    s_waitcnt vmcnt(2)
    s_barrier
    s_waitcnt vmcnt(1)
    s_barrier
    s_waitcnt vmcnt(0)
    s_barrier
    s_add_u32 s56, s2, s48
    s_cmp_lg_u32 s56, 262
    s_cbranch_scc1 K_DONE
    v_mov_b32 v82, 65536
    v_mov_b32 v80, s74
    v_mov_b32 v81, s75
    s_mov_b64 exec, 1
    buffer_store_dwordx2 v[80:81], v82, s[24:27], 0 offen offset:0 sc1
    s_mov_b64 exec, -1
    s_branch K_DONE
K_FALLBACK:
    s_waitcnt vmcnt(0) lgkmcnt(0)
    s_mov_b32 s72, 0x0fffffff
    s_mov_b32 s73, 0x0fffffff
    v_mov_b32 v80, 0xff800000
    s_add_u32 s54, s70, 28672
    s_mov_b32 s67, 64
K_FB1:
    buffer_load_dwordx4 v[64:67], v1, s[16:19], s54 offen sc1
    buffer_load_dwordx4 v[68:71], v1, s[16:19], s54 offen offset:1024 sc1
    s_waitcnt vmcnt(0)
    v_mfma_f32_32x32x16_bf16 v[16:31], v[64:67], v[120:123], 0
    v_mfma_f32_32x32x16_bf16 v[16:31], v[68:71], v[124:127], v[16:31]
    s_nop 15
    v_max3_f32 v80, v80, v16, v17
    v_max3_f32 v80, v80, v18, v19
    v_max3_f32 v80, v80, v20, v21
    v_max3_f32 v80, v80, v22, v23
    v_max3_f32 v80, v80, v24, v25
    v_max3_f32 v80, v80, v26, v27
    v_max3_f32 v80, v80, v28, v29
    v_max3_f32 v80, v80, v30, v31
    s_add_u32 s54, s54, 86016
    s_sub_u32 s67, s67, 1
    s_cmp_lg_u32 s67, 0
    s_cbranch_scc1 K_FB1
    v_mov_b32 v81, v80
    s_nop 1
    v_permlane32_swap_b32 v81, v80
    s_nop 1
    v_max_f32 v80, v80, v81
    v_sub_f32 v32, 0, v80
    v_mov_b32 v48, 0
    v_sub_f32 v33, 0, v80
    v_mov_b32 v49, 0
    v_sub_f32 v34, 0, v80
    v_mov_b32 v50, 0
    v_sub_f32 v35, 0, v80
    v_mov_b32 v51, 0
    v_sub_f32 v36, 0, v80
    v_mov_b32 v52, 0
    v_sub_f32 v37, 0, v80
    v_mov_b32 v53, 0
    v_sub_f32 v38, 0, v80
    v_mov_b32 v54, 0
    v_sub_f32 v39, 0, v80
    v_mov_b32 v55, 0
    v_sub_f32 v40, 0, v80
    v_mov_b32 v56, 0
    v_sub_f32 v41, 0, v80
    v_mov_b32 v57, 0
    v_sub_f32 v42, 0, v80
    v_mov_b32 v58, 0
    v_sub_f32 v43, 0, v80
    v_mov_b32 v59, 0
    v_sub_f32 v44, 0, v80
    v_mov_b32 v60, 0
    v_sub_f32 v45, 0, v80
    v_mov_b32 v61, 0
    v_sub_f32 v46, 0, v80
    v_mov_b32 v62, 0
    v_sub_f32 v47, 0, v80
    v_mov_b32 v63, 0
    v_and_b32 v81, 31, v0
    v_cmp_eq_u32 vcc, 28, v81
    s_nop 0
    v_mov_b32 v81, 0x3f803f80
    v_cndmask_b32 v72, 0, v81, vcc
    v_cndmask_b32 v73, 0, v81, vcc
    v_cndmask_b32 v74, 0, v81, vcc
    v_cndmask_b32 v75, 0, v81, vcc
    v_cndmask_b32 v76, 0, v81, vcc
    v_cndmask_b32 v77, 0, v81, vcc
    v_cndmask_b32 v78, 0, v81, vcc
    v_cndmask_b32 v79, 0, v81, vcc
    s_add_u32 s54, s70, 28672
    s_lshr_b32 s55, s49, 4
    s_mul_i32 s55, s55, 5505024
    s_mul_i32 s56, s51, 448
    s_add_u32 s55, s55, s56
    s_add_u32 s55, s55, 57344
    s_mov_b32 s67, 64
K_FB2:
    s_add_u32 s56, s55, 14336
    buffer_load_dwordx4 v[64:67], v1, s[16:19], s54 offen sc1
    buffer_load_dwordx4 v[68:71], v1, s[16:19], s54 offen offset:1024 sc1
    s_mov_b64 exec, s[72:73]
    buffer_load_dwordx4 v[72:75], v2, s[16:19], s55 offen sc1
    buffer_load_dwordx4 v[76:79], v2, s[16:19], s56 offen sc1
    s_mov_b64 exec, -1
    s_waitcnt vmcnt(0)
    v_mfma_f32_32x32x16_bf16 v[16:31], v[64:67], v[120:123], v[32:47]
    v_mfma_f32_32x32x16_bf16 v[16:31], v[68:71], v[124:127], v[16:31]
    s_nop 15
    v_exp_f32 v16, v16
    v_exp_f32 v17, v17
    v_exp_f32 v18, v18
    v_exp_f32 v19, v19
    v_exp_f32 v20, v20
    v_exp_f32 v21, v21
    v_exp_f32 v22, v22
    v_exp_f32 v23, v23
    v_exp_f32 v24, v24
    v_exp_f32 v25, v25
    v_exp_f32 v26, v26
    v_exp_f32 v27, v27
    v_exp_f32 v28, v28
    v_exp_f32 v29, v29
    v_exp_f32 v30, v30
    v_exp_f32 v31, v31
    s_nop 3
    v_smfmac_f32_32x32x32_bf16 v[48:63], v[72:75], v[16:23], v15
    v_smfmac_f32_32x32x32_bf16 v[48:63], v[76:79], v[24:31], v15
    s_nop 15
    s_add_u32 s54, s54, 86016
    s_add_u32 s55, s55, 86016
    s_sub_u32 s67, s67, 1
    s_cmp_lg_u32 s67, 0
    s_cbranch_scc1 K_FB2
    v_mov_b32 v80, v60
    v_mov_b32 v81, v60
    s_nop 1
    v_permlane32_swap_b32 v81, v80
    v_cmp_gt_u32 vcc, 32, v0
    s_branch K_FINISH
.section .rodata,"a"
.p2align 6
.amdhsa_kernel gated_mix__mha_block__mha_block__prompt_kernel
  .amdhsa_next_free_vgpr 256
  .amdhsa_next_free_sgpr 102
  .amdhsa_accum_offset 256
  .amdhsa_group_segment_fixed_size 0
  .amdhsa_kernarg_size 80
  .amdhsa_user_sgpr_count 2
  .amdhsa_user_sgpr_kernarg_segment_ptr 1
  .amdhsa_system_sgpr_workgroup_id_x 1
.end_amdhsa_kernel
```
